```python
import torch

def _softmax(x, axis=-1):
    return torch.softmax(x, dim=axis)
def _gelu(x):
    return torch.nn.functional.gelu(x, approximate="tanh")
def _silu(x):
    return torch.nn.functional.silu(x)
def _sigmoid(x):
    return torch.sigmoid(x)
def _layernorm(x, axis=-1, eps=1e-5):
    m = x.mean(dim=axis, keepdim=True)
    v = x.var(dim=axis, keepdim=True, unbiased=False)
    return (x - m) / torch.sqrt(v + eps)
def _scatter_add(tgt, idx, src, axis=0):
    return tgt.clone().index_add_(axis, idx, src)
def _segment_sum(src, seg, n):
    out = torch.zeros((n,) + src.shape[1:], dtype=src.dtype)
    return out.index_add_(0, seg, src)
def _pad(x, pw):
    flat = tuple(v for pair in reversed(pw) for v in pair)
    return torch.nn.functional.pad(x, flat)

kernel_name = 'concat_heads__ssm_conv_s4__softmax_full_mha__prompt'

def setup_inputs():

    _w = (lambda a: (lambda t: t.to(torch.bfloat16) if t.is_floating_point() else t)(torch.as_tensor(a)))
    def _A_setup():
        B, L, D, N = 1, 2048, 576, 128
        A_re = -(lambda _x: torch.exp(torch.as_tensor(_x)))((lambda *s: torch.randn(*s, dtype=torch.bfloat16) * 6.4)(D, N))
        A_im = torch.pi * (lambda *s: torch.randn(*s, dtype=torch.bfloat16) * 0.1)(D, N)
        B_re = (lambda *s: torch.randn(*s, dtype=torch.bfloat16) * 0.2)(D, N)
        B_im = (lambda *s: torch.randn(*s, dtype=torch.bfloat16) * 0.2)(D, N)
        C_re = (lambda *s: torch.randn(*s, dtype=torch.bfloat16) * 0.2)(D, N)
        C_im = (lambda *s: torch.randn(*s, dtype=torch.bfloat16) * 0.2)(D, N)
        log_dt = (lambda *s: torch.randn(*s, dtype=torch.bfloat16) * 0.1)(D) * 0.5 - 4.0
        Dskip = (lambda *s: torch.randn(*s, dtype=torch.bfloat16) * 0.1)(D)
        return {
            "u": _w((lambda *s: torch.randn(*s, dtype=torch.bfloat16) * 0.05)(B, L, D)),
            "A_re": _w(A_re),
            "A_im": _w(A_im),
            "B_re": _w(B_re),
            "B_im": _w(B_im),
            "C_re": _w(C_re),
            "C_im": _w(C_im),
            "log_dt": _w(log_dt),
            "Dskip": _w(Dskip),
        }
    _A_in = _A_setup()

    def _B_setup():
        B, S, D = 1, 2048, 576
        return {
            "x": _w((lambda *s: torch.randn(*s, dtype=torch.bfloat16) * 0.2)(B, S, D)),
            "wqkv": _w((lambda *s: torch.randn(*s, dtype=torch.bfloat16) * 0.2)(D, 3 * D)),
            "wo": _w((lambda *s: torch.randn(*s, dtype=torch.bfloat16) * 0.05)(D, D)),
        }
    _B_in = _B_setup()

    return {
        "A_u": _A_in["u"],
        "A_A_re": _A_in["A_re"],
        "A_A_im": _A_in["A_im"],
        "A_B_re": _A_in["B_re"],
        "A_B_im": _A_in["B_im"],
        "A_C_re": _A_in["C_re"],
        "A_C_im": _A_in["C_im"],
        "A_log_dt": _A_in["log_dt"],
        "A_Dskip": _A_in["Dskip"],
        "B_x": _B_in["x"],
        "B_wqkv": _B_in["wqkv"],
        "B_wo": _B_in["wo"],
    }

def reference(A_u, A_A_re, A_A_im, A_B_re, A_B_im, A_C_re, A_C_im, A_log_dt, A_Dskip, B_x, B_wqkv, B_wo):
    def _A_ref(u, A_re, A_im, B_re, B_im, C_re, C_im, log_dt, Dskip):
        Bsz, L, D = u.shape
        dt = torch.exp(log_dt)[:, None]
        A = A_re + 1j * A_im
        Bc = B_re + 1j * B_im
        Cc = C_re + 1j * C_im
        logdA = dt * A
        dB = dt * Bc
        l = (lambda x, dt: x.to(dt))(torch.arange(L), A_re.dtype)
        P = torch.exp(logdA[:, :, None] * l[None, None, :])
        K = torch.einsum("dn,dnl,dn->dl", Cc, P, dB).real
        L2 = 2 * L
        Kp = _pad(K, ((0, 0), (0, L)))
        up = (lambda x, *d: x.permute(*d))(u, 0, 2, 1)
        up = _pad(up, ((0, 0), (0, 0), (0, L)))
        Kf = (lambda x, axes=(-2,-1): torch.fft.rfft2(x.float(), dim=axes))(Kp[:, None, :], axes=(-2, -1))
        Uf = (lambda x, axes=(-2,-1): torch.fft.rfft2(x.float(), dim=axes))(up[:, :, None, :], axes=(-2, -1))
        Yf = Uf * Kf[None, :, :, :]
        y = (lambda x, s, axes=(-2,-1): torch.fft.irfft2(x, s=s, dim=axes).to(torch.bfloat16))(Yf, (1, L2), axes=(-2, -1))[:, :, 0, :L]
        y = (lambda x, *d: x.permute(*d))(y, 0, 2, 1) + u * Dskip[None, None, :]
        return y

    def _B_ref(x, wqkv, wo):
        B, S, D = x.shape
        H = 32; Dh = D // H
        qkv = (lambda x, *d: x.permute(*d))((x @ wqkv).reshape(B, S, 3, H, Dh), 2, 0, 3, 1, 4)
        q, k, v = qkv[0], qkv[1], qkv[2]
        scale = Dh ** -0.5
        scores = torch.einsum("bhqd,bhkd->bhqk", q, k) * scale
        p = _softmax(scores, axis=-1)
        o = torch.einsum("bhqk,bhkd->bhqd", p, v)
        return (lambda x, *d: x.permute(*d))(o, 0, 2, 1, 3).reshape(B, S, D) @ wo

    a = _A_ref(A_u, A_A_re, A_A_im, A_B_re, A_B_im, A_C_re, A_C_im, A_log_dt, A_Dskip)
    b = _B_ref(B_x, B_wqkv, B_wo)
    return torch.concatenate([a, b], axis=-1)
```

```asm
; @launch kernel=l1_kernel grid=(496,1,1) block=(256,1,1) lds=80896
; @launch kernel=attn_kernel grid=(256,1,1) block=(512,1,1) lds=155648
; @launch kernel=l3_kernel grid=(256,1,1) block=(256,1,1) lds=110592
.amdgcn_target "amdgcn-amd-amdhsa--gfx950"
.text
.globl l1_kernel
.p2align 8
.type l1_kernel,@function
l1_kernel:
  s_cmp_lt_u32 s2, 16
  s_cbranch_scc1 l1_pf
  s_sub_u32 s2, s2, 16
  s_cmp_ge_u32 s2, 480
  s_cbranch_scc1 l1_kernel_end
  s_cmp_ge_u32 s2, 192
  s_cbranch_scc1 l1k
  s_load_dwordx4 s[4:7], s[0:1], 72
  s_load_dwordx2 s[8:9], s[0:1], 112
  s_and_b32 s10, s2, 7
  s_lshr_b32 s11, s2, 3
  s_lshr_b32 s24, s10, 1
  s_lshl_b32 s24, s24, 2
  s_and_b32 s25, s11, 3
  s_add_u32 s24, s24, s25
  s_and_b32 s25, s10, 1
  s_mul_i32 s25, s25, 6
  s_lshr_b32 s26, s11, 2
  s_add_u32 s25, s25, s26
  s_lshr_b32 s26, s25, 2
  s_and_b32 s27, s25, 3
  v_and_b32 v142, 63, v0
  v_lshrrev_b32 v143, 6, v0
  s_mul_i32 s29, s25, 288
  v_readfirstlane_b32 s28, v143
  s_mul_i32 s30, s24, 147456
  v_lshrrev_b32 v143, 3, v142
  v_mul_u32_u24 v138, 1152, v143
  v_lshrrev_b32 v144, 4, v142
  v_and_b32 v145, 7, v142
  v_xor_b32 v144, v144, v145
  v_xor_b32 v145, 4, v144
  v_lshl_add_u32 v158, v145, 4, v138
  v_lshl_add_u32 v138, v144, 4, v138
  s_add_u32 s31, s28, 0
  s_lshl_b32 s31, s31, 6
  v_add_u32 v143, s31, v142
  v_mul_u32_u24 v144, 3277, v143
  v_lshrrev_b32 v144, 16, v144
  v_mul_u32_u24 v145, 20, v144
  v_sub_u32 v145, v143, v145
  v_mul_u32_u24 v144, 3456, v144
  v_lshl_add_u32 v139, v145, 4, v144
  v_cmp_gt_u32 vcc, 18, v145
  s_movk_i32 s38, 640
  v_cmp_gt_u32 s[32:33], s38, v143
  v_mov_b32 v146, 0x7ffffff0
  s_nop 0
  s_and_b64 vcc, vcc, s[32:33]
  s_nop 0
  v_cndmask_b32 v139, v146, v139, vcc
  s_add_u32 s31, s28, 4
  s_lshl_b32 s31, s31, 6
  v_add_u32 v143, s31, v142
  v_mul_u32_u24 v144, 3277, v143
  v_lshrrev_b32 v144, 16, v144
  v_mul_u32_u24 v145, 20, v144
  v_sub_u32 v145, v143, v145
  v_mul_u32_u24 v144, 3456, v144
  v_lshl_add_u32 v140, v145, 4, v144
  v_cmp_gt_u32 vcc, 18, v145
  s_movk_i32 s38, 640
  v_cmp_gt_u32 s[32:33], s38, v143
  v_mov_b32 v146, 0x7ffffff0
  s_nop 0
  s_and_b64 vcc, vcc, s[32:33]
  s_nop 0
  v_cndmask_b32 v140, v146, v140, vcc
  s_add_u32 s31, s28, 8
  s_lshl_b32 s31, s31, 6
  v_add_u32 v143, s31, v142
  v_mul_u32_u24 v144, 3277, v143
  v_lshrrev_b32 v144, 16, v144
  v_mul_u32_u24 v145, 20, v144
  v_sub_u32 v145, v143, v145
  v_mul_u32_u24 v144, 3456, v144
  v_lshl_add_u32 v141, v145, 4, v144
  v_cmp_gt_u32 vcc, 18, v145
  s_movk_i32 s38, 640
  v_cmp_gt_u32 s[32:33], s38, v143
  v_mov_b32 v146, 0x7ffffff0
  s_nop 0
  s_and_b64 vcc, vcc, s[32:33]
  s_nop 0
  v_cndmask_b32 v141, v146, v141, vcc
  s_waitcnt lgkmcnt(0)
  s_add_u32 s12, s4, s30
  s_addc_u32 s13, s5, 0
  s_mov_b32 s14, 147456
  s_mov_b32 s15, 0x00020000
  s_add_u32 s16, s6, s29
  s_addc_u32 s17, s7, 0
  s_sub_u32 s18, 1990656, s29
  s_mov_b32 s19, 0x00020000
  s_mul_i32 s34, s28, 36864
  s_lshl_b32 s35, s28, 12
  s_lshl_b32 s36, s28, 10
  s_cmp_lt_u32 s28, 2
  s_cselect_b32 s37, 1, 0
  s_add_u32 s36, s36, 49152
  s_and_b32 s46, s24, 3
  s_lshl_b32 s46, s46, 1
  s_cmp_ge_u32 s25, 6
  s_cselect_b32 s47, 6, 0
  s_sub_u32 s47, s25, s47
  s_mul_i32 s47, s47, 7
  s_add_u32 s46, s46, s47
  s_mul_i32 s47, s46, 7282
  s_lshr_b32 s47, s47, 16
  s_mul_i32 s47, s47, 9
  s_sub_u32 s46, s46, s47
  s_add_u32 s60, s36, 8192
  s_cmp_eq_u32 s37, 1
  s_mov_b32 s56, 79872
  s_cselect_b32 s60, s60, s56
  s_add_u32 s61, s36, 18432
  s_cmp_eq_u32 s37, 1
  s_mov_b32 s56, 79872
  s_cselect_b32 s61, s61, s56
  s_add_u32 s62, s36, 28672
  s_cmp_eq_u32 s37, 1
  s_mov_b32 s56, 79872
  s_cselect_b32 s62, s62, s56
  s_lshl_b32 s64, s46, 7
  s_add_u32 s64, s64, s34
  s_mul_i32 s67, s46, 221184
  s_mul_i32 s68, s46, 221184
  s_add_u32 s68, s68, 110592
  s_add_u32 s46, s46, 1
  s_cmp_eq_u32 s46, 9
  s_cselect_b32 s46, 0, s46
  s_lshl_b32 s65, s46, 7
  s_add_u32 s65, s65, s34
  s_mul_i32 s69, s46, 221184
  s_mul_i32 s70, s46, 221184
  s_add_u32 s70, s70, 110592
  s_add_u32 s46, s46, 1
  s_cmp_eq_u32 s46, 9
  s_cselect_b32 s46, 0, s46
  s_add_u32 s44, s64, 0
  s_add_u32 m0, s35, 0
  s_nop 0
  buffer_load_dwordx4 v138, s[12:15], s44 offen lds
  s_add_u32 s44, s64, 9216
  s_add_u32 m0, s35, 1024
  s_nop 0
  buffer_load_dwordx4 v158, s[12:15], s44 offen lds
  s_add_u32 s44, s64, 18432
  s_add_u32 m0, s35, 2048
  s_nop 0
  buffer_load_dwordx4 v138, s[12:15], s44 offen lds
  s_add_u32 s44, s64, 27648
  s_add_u32 m0, s35, 3072
  s_nop 0
  buffer_load_dwordx4 v158, s[12:15], s44 offen lds
  s_add_u32 m0, s36, 0
  s_nop 0
  buffer_load_dwordx4 v139, s[16:19], s67 offen lds
  s_add_u32 m0, s36, 4096
  s_nop 0
  buffer_load_dwordx4 v140, s[16:19], s67 offen lds
  s_mov_b32 m0, s60
  s_nop 0
  buffer_load_dwordx4 v141, s[16:19], s67 offen lds
  s_add_u32 m0, s36, 10240
  s_nop 0
  buffer_load_dwordx4 v139, s[16:19], s68 offen lds
  s_add_u32 m0, s36, 14336
  s_nop 0
  buffer_load_dwordx4 v140, s[16:19], s68 offen lds
  s_mov_b32 m0, s61
  s_nop 0
  buffer_load_dwordx4 v141, s[16:19], s68 offen lds
  s_add_u32 s44, s65, 0
  s_add_u32 m0, s35, 16384
  s_nop 0
  buffer_load_dwordx4 v138, s[12:15], s44 offen lds
  s_add_u32 s44, s65, 9216
  s_add_u32 m0, s35, 17408
  s_nop 0
  buffer_load_dwordx4 v158, s[12:15], s44 offen lds
  s_add_u32 s44, s65, 18432
  s_add_u32 m0, s35, 18432
  s_nop 0
  buffer_load_dwordx4 v138, s[12:15], s44 offen lds
  s_add_u32 s44, s65, 27648
  s_add_u32 m0, s35, 19456
  s_nop 0
  buffer_load_dwordx4 v158, s[12:15], s44 offen lds
  s_add_u32 m0, s36, 20480
  s_nop 0
  buffer_load_dwordx4 v139, s[16:19], s69 offen lds
  s_add_u32 m0, s36, 24576
  s_nop 0
  buffer_load_dwordx4 v140, s[16:19], s69 offen lds
  s_mov_b32 m0, s62
  s_nop 0
  buffer_load_dwordx4 v141, s[16:19], s69 offen lds
  s_mov_b32 s73, s70
  v_and_b32 v143, 31, v142
  v_lshrrev_b32 v144, 5, v142
  v_lshrrev_b32 v145, 1, v143
  v_and_b32 v145, 7, v145
  v_xor_b32 v145, v145, v144
  v_lshlrev_b32 v132, 7, v143
  v_lshl_add_u32 v132, v145, 4, v132
  v_xor_b32 v133, 32, v132
  v_xor_b32 v134, 64, v132
  v_xor_b32 v135, 96, v132
  s_lshl_b32 s39, s28, 12
  v_add_u32 v128, s39, v132
  v_add_u32 v129, s39, v133
  v_add_u32 v130, s39, v134
  v_add_u32 v131, s39, v135
  v_lshrrev_b32 v145, 2, v142
  v_and_b32 v145, 3, v145
  v_lshl_add_u32 v145, v144, 3, v145
  v_mul_u32_u24 v145, 320, v145
  v_add_u32 v145, 49152, v145
  v_lshrrev_b32 v146, 4, v142
  v_and_b32 v146, 1, v146
  v_and_b32 v147, 3, v142
  v_lshl_add_u32 v146, v146, 2, v147
  s_cmp_eq_u32 s26, 2
  s_cbranch_scc1 l1g_vaddr
  v_lshlrev_b32 v143, 2, v146
  v_mov_b32 v136, 0x86753120
  v_lshrrev_b32 v136, v143, v136
  v_and_b32 v136, 15, v136
  s_mul_i32 s31, s28, 9
  v_add_u32 v136, s31, v136
  v_lshl_add_u32 v136, v136, 3, v145
  v_mul_u32_u24 v137, 9, v147
  v_add_u32 v137, 4, v137
  v_lshl_add_u32 v137, v137, 3, v145
  s_branch l1g_addr_done
l1g_vaddr:
  s_lshl_b32 s31, s28, 3
  v_add_u32 v136, s31, v146
  v_lshl_add_u32 v136, v136, 3, v145
  v_add_u32 v137, 32, v147
  v_lshl_add_u32 v137, v137, 3, v145
l1g_addr_done:
  v_mov_b32 v0, 0
  v_mov_b32 v1, 0
  v_mov_b32 v2, 0
  v_mov_b32 v3, 0
  v_mov_b32 v4, 0
  v_mov_b32 v5, 0
  v_mov_b32 v6, 0
  v_mov_b32 v7, 0
  v_mov_b32 v8, 0
  v_mov_b32 v9, 0
  v_mov_b32 v10, 0
  v_mov_b32 v11, 0
  v_mov_b32 v12, 0
  v_mov_b32 v13, 0
  v_mov_b32 v14, 0
  v_mov_b32 v15, 0
  v_mov_b32 v16, 0
  v_mov_b32 v17, 0
  v_mov_b32 v18, 0
  v_mov_b32 v19, 0
  v_mov_b32 v20, 0
  v_mov_b32 v21, 0
  v_mov_b32 v22, 0
  v_mov_b32 v23, 0
  v_mov_b32 v24, 0
  v_mov_b32 v25, 0
  v_mov_b32 v26, 0
  v_mov_b32 v27, 0
  v_mov_b32 v28, 0
  v_mov_b32 v29, 0
  v_mov_b32 v30, 0
  v_mov_b32 v31, 0
  v_mov_b32 v32, 0
  v_mov_b32 v33, 0
  v_mov_b32 v34, 0
  v_mov_b32 v35, 0
  v_mov_b32 v36, 0
  v_mov_b32 v37, 0
  v_mov_b32 v38, 0
  v_mov_b32 v39, 0
  v_mov_b32 v40, 0
  v_mov_b32 v41, 0
  v_mov_b32 v42, 0
  v_mov_b32 v43, 0
  v_mov_b32 v44, 0
  v_mov_b32 v45, 0
  v_mov_b32 v46, 0
  v_mov_b32 v47, 0
  v_mov_b32 v48, 0
  v_mov_b32 v49, 0
  v_mov_b32 v50, 0
  v_mov_b32 v51, 0
  v_mov_b32 v52, 0
  v_mov_b32 v53, 0
  v_mov_b32 v54, 0
  v_mov_b32 v55, 0
  v_mov_b32 v56, 0
  v_mov_b32 v57, 0
  v_mov_b32 v58, 0
  v_mov_b32 v59, 0
  v_mov_b32 v60, 0
  v_mov_b32 v61, 0
  v_mov_b32 v62, 0
  v_mov_b32 v63, 0
  v_mov_b32 v64, 0
  v_mov_b32 v65, 0
  v_mov_b32 v66, 0
  v_mov_b32 v67, 0
  v_mov_b32 v68, 0
  v_mov_b32 v69, 0
  v_mov_b32 v70, 0
  v_mov_b32 v71, 0
  v_mov_b32 v72, 0
  v_mov_b32 v73, 0
  v_mov_b32 v74, 0
  v_mov_b32 v75, 0
  v_mov_b32 v76, 0
  v_mov_b32 v77, 0
  v_mov_b32 v78, 0
  v_mov_b32 v79, 0
  s_mov_b32 s56, 0
  s_mov_b32 s55, 79872
  s_mov_b32 s47, 0
  s_mov_b32 s67, s73
  s_lshl_b32 s64, s46, 7
  s_add_u32 s64, s64, s34
  s_mul_i32 s68, s46, 221184
  s_mul_i32 s69, s46, 221184
  s_add_u32 s69, s69, 110592
  s_add_u32 s46, s46, 1
  s_cmp_eq_u32 s46, 9
  s_cselect_b32 s46, 0, s46
  s_lshl_b32 s65, s46, 7
  s_add_u32 s65, s65, s34
  s_mul_i32 s70, s46, 221184
  s_mul_i32 s71, s46, 221184
  s_add_u32 s71, s71, 110592
  s_add_u32 s46, s46, 1
  s_cmp_eq_u32 s46, 9
  s_cselect_b32 s46, 0, s46
  s_lshl_b32 s66, s46, 7
  s_add_u32 s66, s66, s34
  s_mul_i32 s72, s46, 221184
  s_mul_i32 s73, s46, 221184
  s_add_u32 s73, s73, 110592
  s_add_u32 s46, s46, 1
  s_cmp_eq_u32 s46, 9
  s_cselect_b32 s46, 0, s46
  s_add_u32 s65, s65, s56
  s_add_u32 s66, s66, s56
  s_add_u32 s70, s70, s56
  s_add_u32 s71, s71, s56
  s_add_u32 s72, s72, s56
  s_waitcnt vmcnt(10)
  s_barrier
  ds_read_b64_tr_b16 v[112:113], v136 offset:0
  ds_read_b64_tr_b16 v[114:115], v136 offset:1280
  ds_read_b128 v[80:83], v132 offset:0
  ds_read_b128 v[84:87], v132 offset:4096
  ds_read_b128 v[88:91], v132 offset:8192
  ds_read_b128 v[92:95], v132 offset:12288
  ds_read_b64_tr_b16 v[120:121], v137 offset:0
  ds_read_b64_tr_b16 v[122:123], v137 offset:1280
  ds_read_b128 v[148:151], v128 offset:0
  s_cmp_eq_u32 s26, 2
  s_cbranch_scc1 l1g_vloop
.p2align 3
l1g_qloop:
  s_waitcnt lgkmcnt(6)
  v_mfma_f32_32x32x16_bf16 v[0:15], v[112:115], v[80:83], v[0:15]
  ds_read_b64_tr_b16 v[116:117], v136 offset:5120
  ds_read_b64_tr_b16 v[118:119], v136 offset:6400
  ds_read_b128 v[96:99], v133 offset:0
  s_waitcnt lgkmcnt(8)
  s_add_u32 s44, s64, 0
  s_add_u32 m0, s35, 32768
  v_mfma_f32_32x32x16_bf16 v[16:31], v[112:115], v[84:87], v[16:31]
  buffer_load_dwordx4 v138, s[12:15], s44 offen lds
  ds_read_b128 v[100:103], v133 offset:4096
  ds_read_b128 v[104:107], v133 offset:8192
  ds_read_b128 v[108:111], v133 offset:12288
  s_waitcnt lgkmcnt(10)
  v_mfma_f32_32x32x16_bf16 v[32:47], v[112:115], v[88:91], v[32:47]
  ds_read_b64_tr_b16 v[124:125], v137 offset:5120
  ds_read_b64_tr_b16 v[126:127], v137 offset:6400
  ds_read_b128 v[152:155], v129 offset:0
  s_waitcnt lgkmcnt(12)
  s_add_u32 s44, s64, 9216
  s_add_u32 m0, s35, 33792
  v_mfma_f32_32x32x16_bf16 v[48:63], v[112:115], v[92:95], v[48:63]
  buffer_load_dwordx4 v158, s[12:15], s44 offen lds
  s_waitcnt lgkmcnt(9)
  v_mfma_f32_32x32x16_bf16 v[64:79], v[120:123], v[148:151], v[64:79]
  s_waitcnt vmcnt(7) lgkmcnt(0)
  s_barrier
  s_waitcnt lgkmcnt(6)
  s_add_u32 m0, s36, 0
  v_mfma_f32_32x32x16_bf16 v[0:15], v[116:119], v[96:99], v[0:15]
  buffer_load_dwordx4 v139, s[16:19], s67 offen lds
  ds_read_b64_tr_b16 v[112:113], v136 offset:10240
  ds_read_b64_tr_b16 v[114:115], v136 offset:11520
  ds_read_b128 v[80:83], v134 offset:0
  s_waitcnt lgkmcnt(8)
  v_mfma_f32_32x32x16_bf16 v[16:31], v[116:119], v[100:103], v[16:31]
  ds_read_b128 v[84:87], v134 offset:4096
  ds_read_b128 v[88:91], v134 offset:8192
  ds_read_b128 v[92:95], v134 offset:12288
  s_waitcnt lgkmcnt(10)
  s_add_u32 m0, s36, 4096
  v_mfma_f32_32x32x16_bf16 v[32:47], v[116:119], v[104:107], v[32:47]
  buffer_load_dwordx4 v140, s[16:19], s67 offen lds
  ds_read_b64_tr_b16 v[120:121], v137 offset:10240
  ds_read_b64_tr_b16 v[122:123], v137 offset:11520
  ds_read_b128 v[148:151], v130 offset:0
  s_waitcnt lgkmcnt(12)
  v_mfma_f32_32x32x16_bf16 v[48:63], v[116:119], v[108:111], v[48:63]
  s_waitcnt lgkmcnt(9)
  s_mov_b32 m0, s60
  v_mfma_f32_32x32x16_bf16 v[64:79], v[124:127], v[152:155], v[64:79]
  buffer_load_dwordx4 v141, s[16:19], s67 offen lds
  s_waitcnt lgkmcnt(6)
  v_mfma_f32_32x32x16_bf16 v[0:15], v[112:115], v[80:83], v[0:15]
  ds_read_b64_tr_b16 v[116:117], v136 offset:15360
  ds_read_b64_tr_b16 v[118:119], v136 offset:16640
  ds_read_b128 v[96:99], v135 offset:0
  s_waitcnt lgkmcnt(8)
  s_add_u32 s44, s64, 18432
  s_add_u32 m0, s35, 34816
  v_mfma_f32_32x32x16_bf16 v[16:31], v[112:115], v[84:87], v[16:31]
  buffer_load_dwordx4 v138, s[12:15], s44 offen lds
  ds_read_b128 v[100:103], v135 offset:4096
  ds_read_b128 v[104:107], v135 offset:8192
  ds_read_b128 v[108:111], v135 offset:12288
  s_waitcnt lgkmcnt(10)
  v_mfma_f32_32x32x16_bf16 v[32:47], v[112:115], v[88:91], v[32:47]
  ds_read_b64_tr_b16 v[124:125], v137 offset:15360
  ds_read_b64_tr_b16 v[126:127], v137 offset:16640
  ds_read_b128 v[152:155], v131 offset:0
  s_waitcnt lgkmcnt(12)
  s_add_u32 s44, s64, 27648
  s_add_u32 m0, s35, 35840
  v_mfma_f32_32x32x16_bf16 v[48:63], v[112:115], v[92:95], v[48:63]
  buffer_load_dwordx4 v158, s[12:15], s44 offen lds
  s_waitcnt lgkmcnt(9)
  v_mfma_f32_32x32x16_bf16 v[64:79], v[120:123], v[148:151], v[64:79]
  s_waitcnt vmcnt(7) lgkmcnt(0)
  s_barrier
  s_waitcnt lgkmcnt(6)
  s_add_u32 m0, s36, 10240
  v_mfma_f32_32x32x16_bf16 v[0:15], v[116:119], v[96:99], v[0:15]
  buffer_load_dwordx4 v139, s[16:19], s68 offen lds
  ds_read_b64_tr_b16 v[112:113], v136 offset:20480
  ds_read_b64_tr_b16 v[114:115], v136 offset:21760
  ds_read_b128 v[80:83], v132 offset:16384
  s_waitcnt lgkmcnt(8)
  v_mfma_f32_32x32x16_bf16 v[16:31], v[116:119], v[100:103], v[16:31]
  ds_read_b128 v[84:87], v132 offset:20480
  ds_read_b128 v[88:91], v132 offset:24576
  ds_read_b128 v[92:95], v132 offset:28672
  s_waitcnt lgkmcnt(10)
  s_add_u32 m0, s36, 14336
  v_mfma_f32_32x32x16_bf16 v[32:47], v[116:119], v[104:107], v[32:47]
  buffer_load_dwordx4 v140, s[16:19], s68 offen lds
  ds_read_b64_tr_b16 v[120:121], v137 offset:20480
  ds_read_b64_tr_b16 v[122:123], v137 offset:21760
  ds_read_b128 v[148:151], v128 offset:16384
  s_waitcnt lgkmcnt(12)
  v_mfma_f32_32x32x16_bf16 v[48:63], v[116:119], v[108:111], v[48:63]
  s_waitcnt lgkmcnt(9)
  s_mov_b32 m0, s61
  v_mfma_f32_32x32x16_bf16 v[64:79], v[124:127], v[152:155], v[64:79]
  buffer_load_dwordx4 v141, s[16:19], s68 offen lds
  s_waitcnt lgkmcnt(6)
  v_mfma_f32_32x32x16_bf16 v[0:15], v[112:115], v[80:83], v[0:15]
  ds_read_b64_tr_b16 v[116:117], v136 offset:25600
  ds_read_b64_tr_b16 v[118:119], v136 offset:26880
  ds_read_b128 v[96:99], v133 offset:16384
  s_waitcnt lgkmcnt(8)
  s_add_u32 s44, s65, 0
  s_add_u32 s45, s35, 0
  s_cmp_eq_u32 s56, 0
  s_cselect_b32 m0, s45, s55
  v_mfma_f32_32x32x16_bf16 v[16:31], v[112:115], v[84:87], v[16:31]
  buffer_load_dwordx4 v138, s[12:15], s44 offen lds
  ds_read_b128 v[100:103], v133 offset:20480
  ds_read_b128 v[104:107], v133 offset:24576
  ds_read_b128 v[108:111], v133 offset:28672
  s_waitcnt lgkmcnt(10)
  v_mfma_f32_32x32x16_bf16 v[32:47], v[112:115], v[88:91], v[32:47]
  ds_read_b64_tr_b16 v[124:125], v137 offset:25600
  ds_read_b64_tr_b16 v[126:127], v137 offset:26880
  ds_read_b128 v[152:155], v129 offset:16384
  s_waitcnt lgkmcnt(12)
  s_add_u32 s44, s65, 9216
  s_add_u32 s45, s35, 1024
  s_cmp_eq_u32 s56, 0
  s_cselect_b32 m0, s45, s55
  v_mfma_f32_32x32x16_bf16 v[48:63], v[112:115], v[92:95], v[48:63]
  buffer_load_dwordx4 v158, s[12:15], s44 offen lds
  s_waitcnt lgkmcnt(9)
  v_mfma_f32_32x32x16_bf16 v[64:79], v[120:123], v[148:151], v[64:79]
  s_waitcnt vmcnt(7) lgkmcnt(0)
  s_barrier
  s_waitcnt lgkmcnt(6)
  s_add_u32 m0, s36, 20480
  v_mfma_f32_32x32x16_bf16 v[0:15], v[116:119], v[96:99], v[0:15]
  buffer_load_dwordx4 v139, s[16:19], s69 offen lds
  ds_read_b64_tr_b16 v[112:113], v136 offset:0
  ds_read_b64_tr_b16 v[114:115], v136 offset:1280
  ds_read_b128 v[80:83], v134 offset:16384
  s_waitcnt lgkmcnt(8)
  v_mfma_f32_32x32x16_bf16 v[16:31], v[116:119], v[100:103], v[16:31]
  ds_read_b128 v[84:87], v134 offset:20480
  ds_read_b128 v[88:91], v134 offset:24576
  ds_read_b128 v[92:95], v134 offset:28672
  s_waitcnt lgkmcnt(10)
  s_add_u32 m0, s36, 24576
  v_mfma_f32_32x32x16_bf16 v[32:47], v[116:119], v[104:107], v[32:47]
  buffer_load_dwordx4 v140, s[16:19], s69 offen lds
  ds_read_b64_tr_b16 v[120:121], v137 offset:0
  ds_read_b64_tr_b16 v[122:123], v137 offset:1280
  ds_read_b128 v[148:151], v130 offset:16384
  s_waitcnt lgkmcnt(12)
  v_mfma_f32_32x32x16_bf16 v[48:63], v[116:119], v[108:111], v[48:63]
  s_waitcnt lgkmcnt(9)
  s_mov_b32 m0, s62
  v_mfma_f32_32x32x16_bf16 v[64:79], v[124:127], v[152:155], v[64:79]
  buffer_load_dwordx4 v141, s[16:19], s69 offen lds
  s_waitcnt lgkmcnt(6)
  v_mfma_f32_32x32x16_bf16 v[0:15], v[112:115], v[80:83], v[0:15]
  ds_read_b64_tr_b16 v[116:117], v136 offset:5120
  ds_read_b64_tr_b16 v[118:119], v136 offset:6400
  ds_read_b128 v[96:99], v135 offset:16384
  s_waitcnt lgkmcnt(8)
  s_add_u32 s44, s65, 18432
  s_add_u32 s45, s35, 2048
  s_cmp_eq_u32 s56, 0
  s_cselect_b32 m0, s45, s55
  v_mfma_f32_32x32x16_bf16 v[16:31], v[112:115], v[84:87], v[16:31]
  buffer_load_dwordx4 v138, s[12:15], s44 offen lds
  ds_read_b128 v[100:103], v135 offset:20480
  ds_read_b128 v[104:107], v135 offset:24576
  ds_read_b128 v[108:111], v135 offset:28672
  s_waitcnt lgkmcnt(10)
  v_mfma_f32_32x32x16_bf16 v[32:47], v[112:115], v[88:91], v[32:47]
  ds_read_b64_tr_b16 v[124:125], v137 offset:5120
  ds_read_b64_tr_b16 v[126:127], v137 offset:6400
  ds_read_b128 v[152:155], v131 offset:16384
  s_waitcnt lgkmcnt(12)
  s_add_u32 s44, s65, 27648
  s_add_u32 s45, s35, 3072
  s_cmp_eq_u32 s56, 0
  s_cselect_b32 m0, s45, s55
  v_mfma_f32_32x32x16_bf16 v[48:63], v[112:115], v[92:95], v[48:63]
  buffer_load_dwordx4 v158, s[12:15], s44 offen lds
  s_waitcnt lgkmcnt(9)
  v_mfma_f32_32x32x16_bf16 v[64:79], v[120:123], v[148:151], v[64:79]
  s_waitcnt vmcnt(7) lgkmcnt(0)
  s_barrier
  s_waitcnt lgkmcnt(6)
  s_add_u32 s45, s36, 0
  s_cmp_eq_u32 s56, 0
  s_cselect_b32 m0, s45, s55
  v_mfma_f32_32x32x16_bf16 v[0:15], v[116:119], v[96:99], v[0:15]
  buffer_load_dwordx4 v139, s[16:19], s70 offen lds
  ds_read_b64_tr_b16 v[112:113], v136 offset:10240
  ds_read_b64_tr_b16 v[114:115], v136 offset:11520
  ds_read_b128 v[80:83], v132 offset:32768
  s_waitcnt lgkmcnt(8)
  v_mfma_f32_32x32x16_bf16 v[16:31], v[116:119], v[100:103], v[16:31]
  ds_read_b128 v[84:87], v132 offset:36864
  ds_read_b128 v[88:91], v132 offset:40960
  ds_read_b128 v[92:95], v132 offset:45056
  s_waitcnt lgkmcnt(10)
  s_add_u32 s45, s36, 4096
  s_cmp_eq_u32 s56, 0
  s_cselect_b32 m0, s45, s55
  v_mfma_f32_32x32x16_bf16 v[32:47], v[116:119], v[104:107], v[32:47]
  buffer_load_dwordx4 v140, s[16:19], s70 offen lds
  ds_read_b64_tr_b16 v[120:121], v137 offset:10240
  ds_read_b64_tr_b16 v[122:123], v137 offset:11520
  ds_read_b128 v[148:151], v128 offset:32768
  s_waitcnt lgkmcnt(12)
  v_mfma_f32_32x32x16_bf16 v[48:63], v[116:119], v[108:111], v[48:63]
  s_waitcnt lgkmcnt(9)
  s_cmp_eq_u32 s56, 0
  s_cselect_b32 m0, s60, s55
  v_mfma_f32_32x32x16_bf16 v[64:79], v[124:127], v[152:155], v[64:79]
  buffer_load_dwordx4 v141, s[16:19], s70 offen lds
  s_waitcnt lgkmcnt(6)
  v_mfma_f32_32x32x16_bf16 v[0:15], v[112:115], v[80:83], v[0:15]
  ds_read_b64_tr_b16 v[116:117], v136 offset:15360
  ds_read_b64_tr_b16 v[118:119], v136 offset:16640
  ds_read_b128 v[96:99], v133 offset:32768
  s_waitcnt lgkmcnt(8)
  s_add_u32 s44, s66, 0
  s_add_u32 s45, s35, 16384
  s_cmp_eq_u32 s56, 0
  s_cselect_b32 m0, s45, s55
  v_mfma_f32_32x32x16_bf16 v[16:31], v[112:115], v[84:87], v[16:31]
  buffer_load_dwordx4 v138, s[12:15], s44 offen lds
  ds_read_b128 v[100:103], v133 offset:36864
  ds_read_b128 v[104:107], v133 offset:40960
  ds_read_b128 v[108:111], v133 offset:45056
  s_waitcnt lgkmcnt(10)
  v_mfma_f32_32x32x16_bf16 v[32:47], v[112:115], v[88:91], v[32:47]
  ds_read_b64_tr_b16 v[124:125], v137 offset:15360
  ds_read_b64_tr_b16 v[126:127], v137 offset:16640
  ds_read_b128 v[152:155], v129 offset:32768
  s_waitcnt lgkmcnt(12)
  s_add_u32 s44, s66, 9216
  s_add_u32 s45, s35, 17408
  s_cmp_eq_u32 s56, 0
  s_cselect_b32 m0, s45, s55
  v_mfma_f32_32x32x16_bf16 v[48:63], v[112:115], v[92:95], v[48:63]
  buffer_load_dwordx4 v158, s[12:15], s44 offen lds
  s_waitcnt lgkmcnt(9)
  v_mfma_f32_32x32x16_bf16 v[64:79], v[120:123], v[148:151], v[64:79]
  s_waitcnt vmcnt(7) lgkmcnt(0)
  s_barrier
  s_waitcnt lgkmcnt(6)
  s_add_u32 s45, s36, 10240
  s_cmp_eq_u32 s56, 0
  s_cselect_b32 m0, s45, s55
  v_mfma_f32_32x32x16_bf16 v[0:15], v[116:119], v[96:99], v[0:15]
  buffer_load_dwordx4 v139, s[16:19], s71 offen lds
  ds_read_b64_tr_b16 v[112:113], v136 offset:20480
  ds_read_b64_tr_b16 v[114:115], v136 offset:21760
  ds_read_b128 v[80:83], v134 offset:32768
  s_waitcnt lgkmcnt(8)
  v_mfma_f32_32x32x16_bf16 v[16:31], v[116:119], v[100:103], v[16:31]
  ds_read_b128 v[84:87], v134 offset:36864
  ds_read_b128 v[88:91], v134 offset:40960
  ds_read_b128 v[92:95], v134 offset:45056
  s_waitcnt lgkmcnt(10)
  s_add_u32 s45, s36, 14336
  s_cmp_eq_u32 s56, 0
  s_cselect_b32 m0, s45, s55
  v_mfma_f32_32x32x16_bf16 v[32:47], v[116:119], v[104:107], v[32:47]
  buffer_load_dwordx4 v140, s[16:19], s71 offen lds
  ds_read_b64_tr_b16 v[120:121], v137 offset:20480
  ds_read_b64_tr_b16 v[122:123], v137 offset:21760
  ds_read_b128 v[148:151], v130 offset:32768
  s_waitcnt lgkmcnt(12)
  v_mfma_f32_32x32x16_bf16 v[48:63], v[116:119], v[108:111], v[48:63]
  s_waitcnt lgkmcnt(9)
  s_cmp_eq_u32 s56, 0
  s_cselect_b32 m0, s61, s55
  v_mfma_f32_32x32x16_bf16 v[64:79], v[124:127], v[152:155], v[64:79]
  buffer_load_dwordx4 v141, s[16:19], s71 offen lds
  s_waitcnt lgkmcnt(6)
  v_mfma_f32_32x32x16_bf16 v[0:15], v[112:115], v[80:83], v[0:15]
  ds_read_b64_tr_b16 v[116:117], v136 offset:25600
  ds_read_b64_tr_b16 v[118:119], v136 offset:26880
  ds_read_b128 v[96:99], v135 offset:32768
  s_waitcnt lgkmcnt(8)
  s_add_u32 s44, s66, 18432
  s_add_u32 s45, s35, 18432
  s_cmp_eq_u32 s56, 0
  s_cselect_b32 m0, s45, s55
  v_mfma_f32_32x32x16_bf16 v[16:31], v[112:115], v[84:87], v[16:31]
  buffer_load_dwordx4 v138, s[12:15], s44 offen lds
  ds_read_b128 v[100:103], v135 offset:36864
  ds_read_b128 v[104:107], v135 offset:40960
  ds_read_b128 v[108:111], v135 offset:45056
  s_waitcnt lgkmcnt(10)
  v_mfma_f32_32x32x16_bf16 v[32:47], v[112:115], v[88:91], v[32:47]
  ds_read_b64_tr_b16 v[124:125], v137 offset:25600
  ds_read_b64_tr_b16 v[126:127], v137 offset:26880
  ds_read_b128 v[152:155], v131 offset:32768
  s_waitcnt lgkmcnt(12)
  s_add_u32 s44, s66, 27648
  s_add_u32 s45, s35, 19456
  s_cmp_eq_u32 s56, 0
  s_cselect_b32 m0, s45, s55
  v_mfma_f32_32x32x16_bf16 v[48:63], v[112:115], v[92:95], v[48:63]
  buffer_load_dwordx4 v158, s[12:15], s44 offen lds
  s_waitcnt lgkmcnt(9)
  v_mfma_f32_32x32x16_bf16 v[64:79], v[120:123], v[148:151], v[64:79]
  s_waitcnt vmcnt(7) lgkmcnt(0)
  s_barrier
  s_waitcnt lgkmcnt(6)
  s_add_u32 s45, s36, 20480
  s_cmp_eq_u32 s56, 0
  s_cselect_b32 m0, s45, s55
  v_mfma_f32_32x32x16_bf16 v[0:15], v[116:119], v[96:99], v[0:15]
  buffer_load_dwordx4 v139, s[16:19], s72 offen lds
  ds_read_b64_tr_b16 v[112:113], v136 offset:0
  ds_read_b64_tr_b16 v[114:115], v136 offset:1280
  ds_read_b128 v[80:83], v132 offset:0
  s_waitcnt lgkmcnt(8)
  v_mfma_f32_32x32x16_bf16 v[16:31], v[116:119], v[100:103], v[16:31]
  ds_read_b128 v[84:87], v132 offset:4096
  ds_read_b128 v[88:91], v132 offset:8192
  ds_read_b128 v[92:95], v132 offset:12288
  s_waitcnt lgkmcnt(10)
  s_add_u32 s45, s36, 24576
  s_cmp_eq_u32 s56, 0
  s_cselect_b32 m0, s45, s55
  v_mfma_f32_32x32x16_bf16 v[32:47], v[116:119], v[104:107], v[32:47]
  buffer_load_dwordx4 v140, s[16:19], s72 offen lds
  ds_read_b64_tr_b16 v[120:121], v137 offset:0
  ds_read_b64_tr_b16 v[122:123], v137 offset:1280
  ds_read_b128 v[148:151], v128 offset:0
  s_waitcnt lgkmcnt(12)
  v_mfma_f32_32x32x16_bf16 v[48:63], v[116:119], v[108:111], v[48:63]
  s_waitcnt lgkmcnt(9)
  s_cmp_eq_u32 s56, 0
  s_cselect_b32 m0, s62, s55
  v_mfma_f32_32x32x16_bf16 v[64:79], v[124:127], v[152:155], v[64:79]
  buffer_load_dwordx4 v141, s[16:19], s72 offen lds
  s_add_u32 s47, s47, 1
  s_cmp_eq_u32 s47, 2
  s_cselect_b32 s56, 0x7ff00000, 0
  s_mov_b32 s67, s73
  s_lshl_b32 s64, s46, 7
  s_add_u32 s64, s64, s34
  s_mul_i32 s68, s46, 221184
  s_mul_i32 s69, s46, 221184
  s_add_u32 s69, s69, 110592
  s_add_u32 s46, s46, 1
  s_cmp_eq_u32 s46, 9
  s_cselect_b32 s46, 0, s46
  s_lshl_b32 s65, s46, 7
  s_add_u32 s65, s65, s34
  s_mul_i32 s70, s46, 221184
  s_mul_i32 s71, s46, 221184
  s_add_u32 s71, s71, 110592
  s_add_u32 s46, s46, 1
  s_cmp_eq_u32 s46, 9
  s_cselect_b32 s46, 0, s46
  s_lshl_b32 s66, s46, 7
  s_add_u32 s66, s66, s34
  s_mul_i32 s72, s46, 221184
  s_mul_i32 s73, s46, 221184
  s_add_u32 s73, s73, 110592
  s_add_u32 s46, s46, 1
  s_cmp_eq_u32 s46, 9
  s_cselect_b32 s46, 0, s46
  s_add_u32 s65, s65, s56
  s_add_u32 s66, s66, s56
  s_add_u32 s70, s70, s56
  s_add_u32 s71, s71, s56
  s_add_u32 s72, s72, s56
  s_cmp_lt_u32 s47, 3
  s_cbranch_scc1 l1g_qloop
  s_branch l1g_epi_q
.p2align 3
l1g_vloop:
  s_waitcnt lgkmcnt(6)
  v_mfma_f32_32x32x16_bf16 v[0:15], v[80:83], v[112:115], v[0:15]
  ds_read_b64_tr_b16 v[116:117], v136 offset:5120
  ds_read_b64_tr_b16 v[118:119], v136 offset:6400
  ds_read_b128 v[96:99], v133 offset:0
  s_waitcnt lgkmcnt(8)
  s_add_u32 s44, s64, 0
  s_add_u32 m0, s35, 32768
  v_mfma_f32_32x32x16_bf16 v[16:31], v[84:87], v[112:115], v[16:31]
  buffer_load_dwordx4 v138, s[12:15], s44 offen lds
  ds_read_b128 v[100:103], v133 offset:4096
  ds_read_b128 v[104:107], v133 offset:8192
  ds_read_b128 v[108:111], v133 offset:12288
  s_waitcnt lgkmcnt(10)
  v_mfma_f32_32x32x16_bf16 v[32:47], v[88:91], v[112:115], v[32:47]
  ds_read_b64_tr_b16 v[124:125], v137 offset:5120
  ds_read_b64_tr_b16 v[126:127], v137 offset:6400
  ds_read_b128 v[152:155], v129 offset:0
  s_waitcnt lgkmcnt(12)
  s_add_u32 s44, s64, 9216
  s_add_u32 m0, s35, 33792
  v_mfma_f32_32x32x16_bf16 v[48:63], v[92:95], v[112:115], v[48:63]
  buffer_load_dwordx4 v158, s[12:15], s44 offen lds
  s_waitcnt lgkmcnt(9)
  v_mfma_f32_32x32x16_bf16 v[64:79], v[148:151], v[120:123], v[64:79]
  s_waitcnt vmcnt(7) lgkmcnt(0)
  s_barrier
  s_waitcnt lgkmcnt(6)
  s_add_u32 m0, s36, 0
  v_mfma_f32_32x32x16_bf16 v[0:15], v[96:99], v[116:119], v[0:15]
  buffer_load_dwordx4 v139, s[16:19], s67 offen lds
  ds_read_b64_tr_b16 v[112:113], v136 offset:10240
  ds_read_b64_tr_b16 v[114:115], v136 offset:11520
  ds_read_b128 v[80:83], v134 offset:0
  s_waitcnt lgkmcnt(8)
  v_mfma_f32_32x32x16_bf16 v[16:31], v[100:103], v[116:119], v[16:31]
  ds_read_b128 v[84:87], v134 offset:4096
  ds_read_b128 v[88:91], v134 offset:8192
  ds_read_b128 v[92:95], v134 offset:12288
  s_waitcnt lgkmcnt(10)
  s_add_u32 m0, s36, 4096
  v_mfma_f32_32x32x16_bf16 v[32:47], v[104:107], v[116:119], v[32:47]
  buffer_load_dwordx4 v140, s[16:19], s67 offen lds
  ds_read_b64_tr_b16 v[120:121], v137 offset:10240
  ds_read_b64_tr_b16 v[122:123], v137 offset:11520
  ds_read_b128 v[148:151], v130 offset:0
  s_waitcnt lgkmcnt(12)
  v_mfma_f32_32x32x16_bf16 v[48:63], v[108:111], v[116:119], v[48:63]
  s_waitcnt lgkmcnt(9)
  s_mov_b32 m0, s60
  v_mfma_f32_32x32x16_bf16 v[64:79], v[152:155], v[124:127], v[64:79]
  buffer_load_dwordx4 v141, s[16:19], s67 offen lds
  s_waitcnt lgkmcnt(6)
  v_mfma_f32_32x32x16_bf16 v[0:15], v[80:83], v[112:115], v[0:15]
  ds_read_b64_tr_b16 v[116:117], v136 offset:15360
  ds_read_b64_tr_b16 v[118:119], v136 offset:16640
  ds_read_b128 v[96:99], v135 offset:0
  s_waitcnt lgkmcnt(8)
  s_add_u32 s44, s64, 18432
  s_add_u32 m0, s35, 34816
  v_mfma_f32_32x32x16_bf16 v[16:31], v[84:87], v[112:115], v[16:31]
  buffer_load_dwordx4 v138, s[12:15], s44 offen lds
  ds_read_b128 v[100:103], v135 offset:4096
  ds_read_b128 v[104:107], v135 offset:8192
  ds_read_b128 v[108:111], v135 offset:12288
  s_waitcnt lgkmcnt(10)
  v_mfma_f32_32x32x16_bf16 v[32:47], v[88:91], v[112:115], v[32:47]
  ds_read_b64_tr_b16 v[124:125], v137 offset:15360
  ds_read_b64_tr_b16 v[126:127], v137 offset:16640
  ds_read_b128 v[152:155], v131 offset:0
  s_waitcnt lgkmcnt(12)
  s_add_u32 s44, s64, 27648
  s_add_u32 m0, s35, 35840
  v_mfma_f32_32x32x16_bf16 v[48:63], v[92:95], v[112:115], v[48:63]
  buffer_load_dwordx4 v158, s[12:15], s44 offen lds
  s_waitcnt lgkmcnt(9)
  v_mfma_f32_32x32x16_bf16 v[64:79], v[148:151], v[120:123], v[64:79]
  s_waitcnt vmcnt(7) lgkmcnt(0)
  s_barrier
  s_waitcnt lgkmcnt(6)
  s_add_u32 m0, s36, 10240
  v_mfma_f32_32x32x16_bf16 v[0:15], v[96:99], v[116:119], v[0:15]
  buffer_load_dwordx4 v139, s[16:19], s68 offen lds
  ds_read_b64_tr_b16 v[112:113], v136 offset:20480
  ds_read_b64_tr_b16 v[114:115], v136 offset:21760
  ds_read_b128 v[80:83], v132 offset:16384
  s_waitcnt lgkmcnt(8)
  v_mfma_f32_32x32x16_bf16 v[16:31], v[100:103], v[116:119], v[16:31]
  ds_read_b128 v[84:87], v132 offset:20480
  ds_read_b128 v[88:91], v132 offset:24576
  ds_read_b128 v[92:95], v132 offset:28672
  s_waitcnt lgkmcnt(10)
  s_add_u32 m0, s36, 14336
  v_mfma_f32_32x32x16_bf16 v[32:47], v[104:107], v[116:119], v[32:47]
  buffer_load_dwordx4 v140, s[16:19], s68 offen lds
  ds_read_b64_tr_b16 v[120:121], v137 offset:20480
  ds_read_b64_tr_b16 v[122:123], v137 offset:21760
  ds_read_b128 v[148:151], v128 offset:16384
  s_waitcnt lgkmcnt(12)
  v_mfma_f32_32x32x16_bf16 v[48:63], v[108:111], v[116:119], v[48:63]
  s_waitcnt lgkmcnt(9)
  s_mov_b32 m0, s61
  v_mfma_f32_32x32x16_bf16 v[64:79], v[152:155], v[124:127], v[64:79]
  buffer_load_dwordx4 v141, s[16:19], s68 offen lds
  s_waitcnt lgkmcnt(6)
  v_mfma_f32_32x32x16_bf16 v[0:15], v[80:83], v[112:115], v[0:15]
  ds_read_b64_tr_b16 v[116:117], v136 offset:25600
  ds_read_b64_tr_b16 v[118:119], v136 offset:26880
  ds_read_b128 v[96:99], v133 offset:16384
  s_waitcnt lgkmcnt(8)
  s_add_u32 s44, s65, 0
  s_add_u32 s45, s35, 0
  s_cmp_eq_u32 s56, 0
  s_cselect_b32 m0, s45, s55
  v_mfma_f32_32x32x16_bf16 v[16:31], v[84:87], v[112:115], v[16:31]
  buffer_load_dwordx4 v138, s[12:15], s44 offen lds
  ds_read_b128 v[100:103], v133 offset:20480
  ds_read_b128 v[104:107], v133 offset:24576
  ds_read_b128 v[108:111], v133 offset:28672
  s_waitcnt lgkmcnt(10)
  v_mfma_f32_32x32x16_bf16 v[32:47], v[88:91], v[112:115], v[32:47]
  ds_read_b64_tr_b16 v[124:125], v137 offset:25600
  ds_read_b64_tr_b16 v[126:127], v137 offset:26880
  ds_read_b128 v[152:155], v129 offset:16384
  s_waitcnt lgkmcnt(12)
  s_add_u32 s44, s65, 9216
  s_add_u32 s45, s35, 1024
  s_cmp_eq_u32 s56, 0
  s_cselect_b32 m0, s45, s55
  v_mfma_f32_32x32x16_bf16 v[48:63], v[92:95], v[112:115], v[48:63]
  buffer_load_dwordx4 v158, s[12:15], s44 offen lds
  s_waitcnt lgkmcnt(9)
  v_mfma_f32_32x32x16_bf16 v[64:79], v[148:151], v[120:123], v[64:79]
  s_waitcnt vmcnt(7) lgkmcnt(0)
  s_barrier
  s_waitcnt lgkmcnt(6)
  s_add_u32 m0, s36, 20480
  v_mfma_f32_32x32x16_bf16 v[0:15], v[96:99], v[116:119], v[0:15]
  buffer_load_dwordx4 v139, s[16:19], s69 offen lds
  ds_read_b64_tr_b16 v[112:113], v136 offset:0
  ds_read_b64_tr_b16 v[114:115], v136 offset:1280
  ds_read_b128 v[80:83], v134 offset:16384
  s_waitcnt lgkmcnt(8)
  v_mfma_f32_32x32x16_bf16 v[16:31], v[100:103], v[116:119], v[16:31]
  ds_read_b128 v[84:87], v134 offset:20480
  ds_read_b128 v[88:91], v134 offset:24576
  ds_read_b128 v[92:95], v134 offset:28672
  s_waitcnt lgkmcnt(10)
  s_add_u32 m0, s36, 24576
  v_mfma_f32_32x32x16_bf16 v[32:47], v[104:107], v[116:119], v[32:47]
  buffer_load_dwordx4 v140, s[16:19], s69 offen lds
  ds_read_b64_tr_b16 v[120:121], v137 offset:0
  ds_read_b64_tr_b16 v[122:123], v137 offset:1280
  ds_read_b128 v[148:151], v130 offset:16384
  s_waitcnt lgkmcnt(12)
  v_mfma_f32_32x32x16_bf16 v[48:63], v[108:111], v[116:119], v[48:63]
  s_waitcnt lgkmcnt(9)
  s_mov_b32 m0, s62
  v_mfma_f32_32x32x16_bf16 v[64:79], v[152:155], v[124:127], v[64:79]
  buffer_load_dwordx4 v141, s[16:19], s69 offen lds
  s_waitcnt lgkmcnt(6)
  v_mfma_f32_32x32x16_bf16 v[0:15], v[80:83], v[112:115], v[0:15]
  ds_read_b64_tr_b16 v[116:117], v136 offset:5120
  ds_read_b64_tr_b16 v[118:119], v136 offset:6400
  ds_read_b128 v[96:99], v135 offset:16384
  s_waitcnt lgkmcnt(8)
  s_add_u32 s44, s65, 18432
  s_add_u32 s45, s35, 2048
  s_cmp_eq_u32 s56, 0
  s_cselect_b32 m0, s45, s55
  v_mfma_f32_32x32x16_bf16 v[16:31], v[84:87], v[112:115], v[16:31]
  buffer_load_dwordx4 v138, s[12:15], s44 offen lds
  ds_read_b128 v[100:103], v135 offset:20480
  ds_read_b128 v[104:107], v135 offset:24576
  ds_read_b128 v[108:111], v135 offset:28672
  s_waitcnt lgkmcnt(10)
  v_mfma_f32_32x32x16_bf16 v[32:47], v[88:91], v[112:115], v[32:47]
  ds_read_b64_tr_b16 v[124:125], v137 offset:5120
  ds_read_b64_tr_b16 v[126:127], v137 offset:6400
  ds_read_b128 v[152:155], v131 offset:16384
  s_waitcnt lgkmcnt(12)
  s_add_u32 s44, s65, 27648
  s_add_u32 s45, s35, 3072
  s_cmp_eq_u32 s56, 0
  s_cselect_b32 m0, s45, s55
  v_mfma_f32_32x32x16_bf16 v[48:63], v[92:95], v[112:115], v[48:63]
  buffer_load_dwordx4 v158, s[12:15], s44 offen lds
  s_waitcnt lgkmcnt(9)
  v_mfma_f32_32x32x16_bf16 v[64:79], v[148:151], v[120:123], v[64:79]
  s_waitcnt vmcnt(7) lgkmcnt(0)
  s_barrier
  s_waitcnt lgkmcnt(6)
  s_add_u32 s45, s36, 0
  s_cmp_eq_u32 s56, 0
  s_cselect_b32 m0, s45, s55
  v_mfma_f32_32x32x16_bf16 v[0:15], v[96:99], v[116:119], v[0:15]
  buffer_load_dwordx4 v139, s[16:19], s70 offen lds
  ds_read_b64_tr_b16 v[112:113], v136 offset:10240
  ds_read_b64_tr_b16 v[114:115], v136 offset:11520
  ds_read_b128 v[80:83], v132 offset:32768
  s_waitcnt lgkmcnt(8)
  v_mfma_f32_32x32x16_bf16 v[16:31], v[100:103], v[116:119], v[16:31]
  ds_read_b128 v[84:87], v132 offset:36864
  ds_read_b128 v[88:91], v132 offset:40960
  ds_read_b128 v[92:95], v132 offset:45056
  s_waitcnt lgkmcnt(10)
  s_add_u32 s45, s36, 4096
  s_cmp_eq_u32 s56, 0
  s_cselect_b32 m0, s45, s55
  v_mfma_f32_32x32x16_bf16 v[32:47], v[104:107], v[116:119], v[32:47]
  buffer_load_dwordx4 v140, s[16:19], s70 offen lds
  ds_read_b64_tr_b16 v[120:121], v137 offset:10240
  ds_read_b64_tr_b16 v[122:123], v137 offset:11520
  ds_read_b128 v[148:151], v128 offset:32768
  s_waitcnt lgkmcnt(12)
  v_mfma_f32_32x32x16_bf16 v[48:63], v[108:111], v[116:119], v[48:63]
  s_waitcnt lgkmcnt(9)
  s_cmp_eq_u32 s56, 0
  s_cselect_b32 m0, s60, s55
  v_mfma_f32_32x32x16_bf16 v[64:79], v[152:155], v[124:127], v[64:79]
  buffer_load_dwordx4 v141, s[16:19], s70 offen lds
  s_waitcnt lgkmcnt(6)
  v_mfma_f32_32x32x16_bf16 v[0:15], v[80:83], v[112:115], v[0:15]
  ds_read_b64_tr_b16 v[116:117], v136 offset:15360
  ds_read_b64_tr_b16 v[118:119], v136 offset:16640
  ds_read_b128 v[96:99], v133 offset:32768
  s_waitcnt lgkmcnt(8)
  s_add_u32 s44, s66, 0
  s_add_u32 s45, s35, 16384
  s_cmp_eq_u32 s56, 0
  s_cselect_b32 m0, s45, s55
  v_mfma_f32_32x32x16_bf16 v[16:31], v[84:87], v[112:115], v[16:31]
  buffer_load_dwordx4 v138, s[12:15], s44 offen lds
  ds_read_b128 v[100:103], v133 offset:36864
  ds_read_b128 v[104:107], v133 offset:40960
  ds_read_b128 v[108:111], v133 offset:45056
  s_waitcnt lgkmcnt(10)
  v_mfma_f32_32x32x16_bf16 v[32:47], v[88:91], v[112:115], v[32:47]
  ds_read_b64_tr_b16 v[124:125], v137 offset:15360
  ds_read_b64_tr_b16 v[126:127], v137 offset:16640
  ds_read_b128 v[152:155], v129 offset:32768
  s_waitcnt lgkmcnt(12)
  s_add_u32 s44, s66, 9216
  s_add_u32 s45, s35, 17408
  s_cmp_eq_u32 s56, 0
  s_cselect_b32 m0, s45, s55
  v_mfma_f32_32x32x16_bf16 v[48:63], v[92:95], v[112:115], v[48:63]
  buffer_load_dwordx4 v158, s[12:15], s44 offen lds
  s_waitcnt lgkmcnt(9)
  v_mfma_f32_32x32x16_bf16 v[64:79], v[148:151], v[120:123], v[64:79]
  s_waitcnt vmcnt(7) lgkmcnt(0)
  s_barrier
  s_waitcnt lgkmcnt(6)
  s_add_u32 s45, s36, 10240
  s_cmp_eq_u32 s56, 0
  s_cselect_b32 m0, s45, s55
  v_mfma_f32_32x32x16_bf16 v[0:15], v[96:99], v[116:119], v[0:15]
  buffer_load_dwordx4 v139, s[16:19], s71 offen lds
  ds_read_b64_tr_b16 v[112:113], v136 offset:20480
  ds_read_b64_tr_b16 v[114:115], v136 offset:21760
  ds_read_b128 v[80:83], v134 offset:32768
  s_waitcnt lgkmcnt(8)
  v_mfma_f32_32x32x16_bf16 v[16:31], v[100:103], v[116:119], v[16:31]
  ds_read_b128 v[84:87], v134 offset:36864
  ds_read_b128 v[88:91], v134 offset:40960
  ds_read_b128 v[92:95], v134 offset:45056
  s_waitcnt lgkmcnt(10)
  s_add_u32 s45, s36, 14336
  s_cmp_eq_u32 s56, 0
  s_cselect_b32 m0, s45, s55
  v_mfma_f32_32x32x16_bf16 v[32:47], v[104:107], v[116:119], v[32:47]
  buffer_load_dwordx4 v140, s[16:19], s71 offen lds
  ds_read_b64_tr_b16 v[120:121], v137 offset:20480
  ds_read_b64_tr_b16 v[122:123], v137 offset:21760
  ds_read_b128 v[148:151], v130 offset:32768
  s_waitcnt lgkmcnt(12)
  v_mfma_f32_32x32x16_bf16 v[48:63], v[108:111], v[116:119], v[48:63]
  s_waitcnt lgkmcnt(9)
  s_cmp_eq_u32 s56, 0
  s_cselect_b32 m0, s61, s55
  v_mfma_f32_32x32x16_bf16 v[64:79], v[152:155], v[124:127], v[64:79]
  buffer_load_dwordx4 v141, s[16:19], s71 offen lds
  s_waitcnt lgkmcnt(6)
  v_mfma_f32_32x32x16_bf16 v[0:15], v[80:83], v[112:115], v[0:15]
  ds_read_b64_tr_b16 v[116:117], v136 offset:25600
  ds_read_b64_tr_b16 v[118:119], v136 offset:26880
  ds_read_b128 v[96:99], v135 offset:32768
  s_waitcnt lgkmcnt(8)
  s_add_u32 s44, s66, 18432
  s_add_u32 s45, s35, 18432
  s_cmp_eq_u32 s56, 0
  s_cselect_b32 m0, s45, s55
  v_mfma_f32_32x32x16_bf16 v[16:31], v[84:87], v[112:115], v[16:31]
  buffer_load_dwordx4 v138, s[12:15], s44 offen lds
  ds_read_b128 v[100:103], v135 offset:36864
  ds_read_b128 v[104:107], v135 offset:40960
  ds_read_b128 v[108:111], v135 offset:45056
  s_waitcnt lgkmcnt(10)
  v_mfma_f32_32x32x16_bf16 v[32:47], v[88:91], v[112:115], v[32:47]
  ds_read_b64_tr_b16 v[124:125], v137 offset:25600
  ds_read_b64_tr_b16 v[126:127], v137 offset:26880
  ds_read_b128 v[152:155], v131 offset:32768
  s_waitcnt lgkmcnt(12)
  s_add_u32 s44, s66, 27648
  s_add_u32 s45, s35, 19456
  s_cmp_eq_u32 s56, 0
  s_cselect_b32 m0, s45, s55
  v_mfma_f32_32x32x16_bf16 v[48:63], v[92:95], v[112:115], v[48:63]
  buffer_load_dwordx4 v158, s[12:15], s44 offen lds
  s_waitcnt lgkmcnt(9)
  v_mfma_f32_32x32x16_bf16 v[64:79], v[148:151], v[120:123], v[64:79]
  s_waitcnt vmcnt(7) lgkmcnt(0)
  s_barrier
  s_waitcnt lgkmcnt(6)
  s_add_u32 s45, s36, 20480
  s_cmp_eq_u32 s56, 0
  s_cselect_b32 m0, s45, s55
  v_mfma_f32_32x32x16_bf16 v[0:15], v[96:99], v[116:119], v[0:15]
  buffer_load_dwordx4 v139, s[16:19], s72 offen lds
  ds_read_b64_tr_b16 v[112:113], v136 offset:0
  ds_read_b64_tr_b16 v[114:115], v136 offset:1280
  ds_read_b128 v[80:83], v132 offset:0
  s_waitcnt lgkmcnt(8)
  v_mfma_f32_32x32x16_bf16 v[16:31], v[100:103], v[116:119], v[16:31]
  ds_read_b128 v[84:87], v132 offset:4096
  ds_read_b128 v[88:91], v132 offset:8192
  ds_read_b128 v[92:95], v132 offset:12288
  s_waitcnt lgkmcnt(10)
  s_add_u32 s45, s36, 24576
  s_cmp_eq_u32 s56, 0
  s_cselect_b32 m0, s45, s55
  v_mfma_f32_32x32x16_bf16 v[32:47], v[104:107], v[116:119], v[32:47]
  buffer_load_dwordx4 v140, s[16:19], s72 offen lds
  ds_read_b64_tr_b16 v[120:121], v137 offset:0
  ds_read_b64_tr_b16 v[122:123], v137 offset:1280
  ds_read_b128 v[148:151], v128 offset:0
  s_waitcnt lgkmcnt(12)
  v_mfma_f32_32x32x16_bf16 v[48:63], v[108:111], v[116:119], v[48:63]
  s_waitcnt lgkmcnt(9)
  s_cmp_eq_u32 s56, 0
  s_cselect_b32 m0, s62, s55
  v_mfma_f32_32x32x16_bf16 v[64:79], v[152:155], v[124:127], v[64:79]
  buffer_load_dwordx4 v141, s[16:19], s72 offen lds
  s_add_u32 s47, s47, 1
  s_cmp_eq_u32 s47, 2
  s_cselect_b32 s56, 0x7ff00000, 0
  s_mov_b32 s67, s73
  s_lshl_b32 s64, s46, 7
  s_add_u32 s64, s64, s34
  s_mul_i32 s68, s46, 221184
  s_mul_i32 s69, s46, 221184
  s_add_u32 s69, s69, 110592
  s_add_u32 s46, s46, 1
  s_cmp_eq_u32 s46, 9
  s_cselect_b32 s46, 0, s46
  s_lshl_b32 s65, s46, 7
  s_add_u32 s65, s65, s34
  s_mul_i32 s70, s46, 221184
  s_mul_i32 s71, s46, 221184
  s_add_u32 s71, s71, 110592
  s_add_u32 s46, s46, 1
  s_cmp_eq_u32 s46, 9
  s_cselect_b32 s46, 0, s46
  s_lshl_b32 s66, s46, 7
  s_add_u32 s66, s66, s34
  s_mul_i32 s72, s46, 221184
  s_mul_i32 s73, s46, 221184
  s_add_u32 s73, s73, 110592
  s_add_u32 s46, s46, 1
  s_cmp_eq_u32 s46, 9
  s_cselect_b32 s46, 0, s46
  s_add_u32 s65, s65, s56
  s_add_u32 s66, s66, s56
  s_add_u32 s70, s70, s56
  s_add_u32 s71, s71, s56
  s_add_u32 s72, s72, s56
  s_cmp_lt_u32 s47, 3
  s_cbranch_scc1 l1g_vloop
  s_branch l1g_epi_v
l1g_epi_q:
  s_waitcnt lgkmcnt(0)
  s_cmp_eq_u32 s26, 0
  s_mov_b32 s55, 0
  s_mov_b32 s56, 2359296
  s_cselect_b32 s30, s55, s56
  s_mov_b32 s55, 2359296
  s_mov_b32 s56, 4849664
  s_cselect_b32 s31, s55, s56
  s_mov_b32 s55, 73728
  s_mov_b32 s56, 151552
  s_cselect_b32 s48, s55, s56
  s_mov_b32 s55, 1152
  s_mov_b32 s56, 2368
  s_cselect_b32 s49, s55, s56
  s_mov_b32 s55, 1051597459
  s_mov_b32 s56, 1065353216
  s_cselect_b32 s50, s55, s56
  s_add_u32 s20, s8, s30
  s_addc_u32 s21, s9, 0
  s_mov_b32 s22, s31
  s_mov_b32 s23, 0x00020000
  s_lshl_b32 s51, s27, 3
  s_lshl_b32 s52, s28, 1
  s_add_u32 s52, s52, s51
  s_mul_i32 s52, s52, s48
  s_lshl_b32 s53, s24, 2
  s_mul_i32 s53, s53, s49
  s_add_u32 s52, s52, s53
  v_lshlrev_b32 v143, 4, v142
  v_mov_b32 v80, s50
  v_mov_b32 v81, s50
  v_pk_mul_f32 v[0:1], v[0:1], v[80:81]
  v_pk_mul_f32 v[2:3], v[2:3], v[80:81]
  v_pk_mul_f32 v[4:5], v[4:5], v[80:81]
  v_pk_mul_f32 v[6:7], v[6:7], v[80:81]
  v_pk_mul_f32 v[8:9], v[8:9], v[80:81]
  v_pk_mul_f32 v[10:11], v[10:11], v[80:81]
  v_pk_mul_f32 v[12:13], v[12:13], v[80:81]
  v_pk_mul_f32 v[14:15], v[14:15], v[80:81]
  v_cvt_pk_bf16_f32 v0, v0, v1
  v_cvt_pk_bf16_f32 v1, v2, v3
  v_cvt_pk_bf16_f32 v2, v4, v5
  v_cvt_pk_bf16_f32 v3, v6, v7
  v_cvt_pk_bf16_f32 v4, v8, v9
  v_cvt_pk_bf16_f32 v5, v10, v11
  v_cvt_pk_bf16_f32 v6, v12, v13
  v_cvt_pk_bf16_f32 v7, v14, v15
  buffer_store_dwordx4 v[0:3], v143, s[20:23], s52 offen
  s_add_u32 s54, s52, s48
  buffer_store_dwordx4 v[4:7], v143, s[20:23], s54 offen
  s_add_u32 s52, s52, s49
  v_pk_mul_f32 v[16:17], v[16:17], v[80:81]
  v_pk_mul_f32 v[18:19], v[18:19], v[80:81]
  v_pk_mul_f32 v[20:21], v[20:21], v[80:81]
  v_pk_mul_f32 v[22:23], v[22:23], v[80:81]
  v_pk_mul_f32 v[24:25], v[24:25], v[80:81]
  v_pk_mul_f32 v[26:27], v[26:27], v[80:81]
  v_pk_mul_f32 v[28:29], v[28:29], v[80:81]
  v_pk_mul_f32 v[30:31], v[30:31], v[80:81]
  v_cvt_pk_bf16_f32 v16, v16, v17
  v_cvt_pk_bf16_f32 v17, v18, v19
  v_cvt_pk_bf16_f32 v18, v20, v21
  v_cvt_pk_bf16_f32 v19, v22, v23
  v_cvt_pk_bf16_f32 v20, v24, v25
  v_cvt_pk_bf16_f32 v21, v26, v27
  v_cvt_pk_bf16_f32 v22, v28, v29
  v_cvt_pk_bf16_f32 v23, v30, v31
  buffer_store_dwordx4 v[16:19], v143, s[20:23], s52 offen
  s_add_u32 s54, s52, s48
  buffer_store_dwordx4 v[20:23], v143, s[20:23], s54 offen
  s_add_u32 s52, s52, s49
  v_pk_mul_f32 v[32:33], v[32:33], v[80:81]
  v_pk_mul_f32 v[34:35], v[34:35], v[80:81]
  v_pk_mul_f32 v[36:37], v[36:37], v[80:81]
  v_pk_mul_f32 v[38:39], v[38:39], v[80:81]
  v_pk_mul_f32 v[40:41], v[40:41], v[80:81]
  v_pk_mul_f32 v[42:43], v[42:43], v[80:81]
  v_pk_mul_f32 v[44:45], v[44:45], v[80:81]
  v_pk_mul_f32 v[46:47], v[46:47], v[80:81]
  v_cvt_pk_bf16_f32 v32, v32, v33
  v_cvt_pk_bf16_f32 v33, v34, v35
  v_cvt_pk_bf16_f32 v34, v36, v37
  v_cvt_pk_bf16_f32 v35, v38, v39
  v_cvt_pk_bf16_f32 v36, v40, v41
  v_cvt_pk_bf16_f32 v37, v42, v43
  v_cvt_pk_bf16_f32 v38, v44, v45
  v_cvt_pk_bf16_f32 v39, v46, v47
  buffer_store_dwordx4 v[32:35], v143, s[20:23], s52 offen
  s_add_u32 s54, s52, s48
  buffer_store_dwordx4 v[36:39], v143, s[20:23], s54 offen
  s_add_u32 s52, s52, s49
  v_pk_mul_f32 v[48:49], v[48:49], v[80:81]
  v_pk_mul_f32 v[50:51], v[50:51], v[80:81]
  v_pk_mul_f32 v[52:53], v[52:53], v[80:81]
  v_pk_mul_f32 v[54:55], v[54:55], v[80:81]
  v_pk_mul_f32 v[56:57], v[56:57], v[80:81]
  v_pk_mul_f32 v[58:59], v[58:59], v[80:81]
  v_pk_mul_f32 v[60:61], v[60:61], v[80:81]
  v_pk_mul_f32 v[62:63], v[62:63], v[80:81]
  v_cvt_pk_bf16_f32 v48, v48, v49
  v_cvt_pk_bf16_f32 v49, v50, v51
  v_cvt_pk_bf16_f32 v50, v52, v53
  v_cvt_pk_bf16_f32 v51, v54, v55
  v_cvt_pk_bf16_f32 v52, v56, v57
  v_cvt_pk_bf16_f32 v53, v58, v59
  v_cvt_pk_bf16_f32 v54, v60, v61
  v_cvt_pk_bf16_f32 v55, v62, v63
  buffer_store_dwordx4 v[48:51], v143, s[20:23], s52 offen
  s_add_u32 s54, s52, s48
  buffer_store_dwordx4 v[52:55], v143, s[20:23], s54 offen
  s_add_u32 s52, s52, s49
  v_pk_mul_f32 v[64:65], v[64:65], v[80:81]
  v_pk_mul_f32 v[66:67], v[66:67], v[80:81]
  v_pk_mul_f32 v[68:69], v[68:69], v[80:81]
  v_pk_mul_f32 v[70:71], v[70:71], v[80:81]
  v_cvt_pk_bf16_f32 v64, v64, v65
  v_cvt_pk_bf16_f32 v65, v66, v67
  v_cvt_pk_bf16_f32 v66, v68, v69
  v_cvt_pk_bf16_f32 v67, v70, v71
  s_mul_i32 s52, s51, s48
  s_lshl_b32 s53, s24, 2
  s_add_u32 s53, s53, s28
  s_mul_i32 s53, s53, s49
  s_add_u32 s52, s52, s53
  s_add_u32 s52, s52, 1024
  v_lshrrev_b32 v144, 5, v142
  s_lshl_b32 s53, s48, 1
  v_mul_lo_u32 v144, v144, s53
  v_and_b32 v145, 31, v142
  v_lshl_add_u32 v144, v145, 2, v144
  s_mul_i32 s53, s48, 0
  s_add_u32 s53, s53, s52
  buffer_store_dword v64, v144, s[20:23], s53 offen
  s_mul_i32 s53, s48, 1
  s_add_u32 s53, s53, s52
  buffer_store_dword v65, v144, s[20:23], s53 offen
  s_mul_i32 s53, s48, 4
  s_add_u32 s53, s53, s52
  buffer_store_dword v66, v144, s[20:23], s53 offen
  s_mul_i32 s53, s48, 5
  s_add_u32 s53, s53, s52
  buffer_store_dword v67, v144, s[20:23], s53 offen
  s_endpgm
l1g_epi_v:
  s_waitcnt lgkmcnt(0)
  s_add_u32 s20, s8, 2359296
  s_addc_u32 s21, s9, 0
  s_mov_b32 s22, 4849664
  s_mov_b32 s23, 0x00020000
  s_lshl_b32 s51, s27, 3
  v_and_b32 v143, 31, v142
  s_lshl_b32 s31, s28, 5
  v_add_u32 v143, s31, v143
  v_mul_u32_u24 v144, 3641, v143
  v_lshrrev_b32 v144, 16, v144
  v_mul_u32_u24 v145, 18, v144
  v_sub_u32 v145, v143, v145
  v_lshrrev_b32 v146, 5, v142
  v_mul_u32_u24 v146, 18, v146
  v_add_u32 v145, v145, v146
  v_add_u32 v144, s51, v144
  s_mov_b32 s53, 151552
  v_mul_lo_u32 v144, v144, s53
  v_lshl_add_u32 v156, v145, 4, v144
  s_lshl_b32 s53, s24, 2
  s_mul_i32 s52, s53, 2368
  s_add_u32 s52, s52, 1152
  v_cvt_pk_bf16_f32 v0, v0, v1
  v_cvt_pk_bf16_f32 v1, v2, v3
  v_cvt_pk_bf16_f32 v2, v4, v5
  v_cvt_pk_bf16_f32 v3, v6, v7
  v_cvt_pk_bf16_f32 v4, v8, v9
  v_cvt_pk_bf16_f32 v5, v10, v11
  v_cvt_pk_bf16_f32 v6, v12, v13
  v_cvt_pk_bf16_f32 v7, v14, v15
  buffer_store_dwordx4 v[0:3], v156, s[20:23], s52 offen
  buffer_store_dwordx4 v[4:7], v156, s[20:23], s52 offen offset:608
  s_add_u32 s52, s52, 2368
  v_cvt_pk_bf16_f32 v16, v16, v17
  v_cvt_pk_bf16_f32 v17, v18, v19
  v_cvt_pk_bf16_f32 v18, v20, v21
  v_cvt_pk_bf16_f32 v19, v22, v23
  v_cvt_pk_bf16_f32 v20, v24, v25
  v_cvt_pk_bf16_f32 v21, v26, v27
  v_cvt_pk_bf16_f32 v22, v28, v29
  v_cvt_pk_bf16_f32 v23, v30, v31
  buffer_store_dwordx4 v[16:19], v156, s[20:23], s52 offen
  buffer_store_dwordx4 v[20:23], v156, s[20:23], s52 offen offset:608
  s_add_u32 s52, s52, 2368
  v_cvt_pk_bf16_f32 v32, v32, v33
  v_cvt_pk_bf16_f32 v33, v34, v35
  v_cvt_pk_bf16_f32 v34, v36, v37
  v_cvt_pk_bf16_f32 v35, v38, v39
  v_cvt_pk_bf16_f32 v36, v40, v41
  v_cvt_pk_bf16_f32 v37, v42, v43
  v_cvt_pk_bf16_f32 v38, v44, v45
  v_cvt_pk_bf16_f32 v39, v46, v47
  buffer_store_dwordx4 v[32:35], v156, s[20:23], s52 offen
  buffer_store_dwordx4 v[36:39], v156, s[20:23], s52 offen offset:608
  s_add_u32 s52, s52, 2368
  v_cvt_pk_bf16_f32 v48, v48, v49
  v_cvt_pk_bf16_f32 v49, v50, v51
  v_cvt_pk_bf16_f32 v50, v52, v53
  v_cvt_pk_bf16_f32 v51, v54, v55
  v_cvt_pk_bf16_f32 v52, v56, v57
  v_cvt_pk_bf16_f32 v53, v58, v59
  v_cvt_pk_bf16_f32 v54, v60, v61
  v_cvt_pk_bf16_f32 v55, v62, v63
  buffer_store_dwordx4 v[48:51], v156, s[20:23], s52 offen
  buffer_store_dwordx4 v[52:55], v156, s[20:23], s52 offen offset:608
  s_add_u32 s52, s52, 2368
  v_and_b32 v143, 31, v142
  v_add_u32 v143, 128, v143
  v_mul_u32_u24 v144, 3641, v143
  v_lshrrev_b32 v144, 16, v144
  v_mul_u32_u24 v145, 18, v144
  v_sub_u32 v145, v143, v145
  v_lshrrev_b32 v146, 5, v142
  v_mul_u32_u24 v146, 18, v146
  v_add_u32 v145, v145, v146
  v_add_u32 v144, s51, v144
  s_mov_b32 s53, 151552
  v_mul_lo_u32 v144, v144, s53
  v_lshl_add_u32 v157, v145, 4, v144
  v_and_b32 v143, 16, v142
  v_cmp_eq_u32 vcc, 0, v143
  v_mov_b32 v146, 0x7ffffff0
  s_nop 0
  v_cndmask_b32 v157, v146, v157, vcc
  v_cvt_pk_bf16_f32 v64, v64, v65
  v_cvt_pk_bf16_f32 v65, v66, v67
  v_cvt_pk_bf16_f32 v66, v68, v69
  v_cvt_pk_bf16_f32 v67, v70, v71
  v_cvt_pk_bf16_f32 v68, v72, v73
  v_cvt_pk_bf16_f32 v69, v74, v75
  v_cvt_pk_bf16_f32 v70, v76, v77
  v_cvt_pk_bf16_f32 v71, v78, v79
  s_lshl_b32 s53, s24, 2
  s_add_u32 s53, s53, s28
  s_mul_i32 s52, s53, 2368
  s_add_u32 s52, s52, 1152
  buffer_store_dwordx4 v[64:67], v157, s[20:23], s52 offen
  buffer_store_dwordx4 v[68:71], v157, s[20:23], s52 offen offset:608
  v_lshrrev_b32 v143, 2, v142
  v_add_u32 v143, s51, v143
  s_mov_b32 s53, 151552
  v_mul_lo_u32 v143, v143, s53
  v_bfe_u32 v144, v142, 1, 1
  v_mul_u32_u24 v144, 608, v144
  v_and_b32 v145, 1, v142
  v_lshl_add_u32 v144, v145, 4, v144
  v_add3_u32 v143, v143, v144, 0
  v_add_u32 v143, 576, v143
  v_cmp_eq_u32 vcc, 0, v145
  v_mov_b32 v4, 0x3f803f80
  s_nop 0
  v_cndmask_b32 v0, 0, v4, vcc
  v_cmp_gt_u32 vcc, 32, v142
  v_mov_b32 v1, v0
  v_mov_b32 v2, v0
  v_mov_b32 v3, v0
  v_cndmask_b32 v143, v146, v143, vcc
  buffer_store_dwordx4 v[0:3], v143, s[20:23], s52 offen
  s_endpgm
l1k:
  s_load_dwordx8 s[4:11], s[0:1], 8
  s_load_dwordx4 s[12:15], s[0:1], 40
  s_load_dwordx2 s[16:17], s[0:1], 56
  s_load_dwordx2 s[18:19], s[0:1], 112
  s_load_dwordx2 s[64:65], s[0:1], 0
  v_lshrrev_b32 v1, 6, v0
  v_and_b32 v0, 63, v0
  v_readfirstlane_b32 s28, v1
  s_sub_u32 s68, s2, 192
  s_lshl_b32 s29, s68, 1
  s_lshr_b32 s26, s28, 1
  s_and_b32 s27, s28, 1
  s_add_u32 s25, s29, s26
  s_getpc_b64 s[20:21]
l1k_pc:
  s_add_u32 s20, s20, l1_idxtab-l1k_pc
  s_addc_u32 s21, s21, 0
  v_lshlrev_b32 v1, 1, v0
  s_lshl_b32 s31, s25, 8
  s_lshl_b32 s22, s27, 7
  s_add_u32 s31, s31, s22
  s_mul_i32 s69, s68, 7282
  s_lshr_b32 s69, s69, 16
  s_mul_i32 s70, s69, 9
  s_sub_u32 s70, s68, s70
  s_waitcnt lgkmcnt(0)
  s_mov_b32 s32, s4
  s_mov_b32 s33, s5
  s_mov_b32 s34, 147456
  s_mov_b32 s35, 0x00020000
  buffer_load_ushort v8, v1, s[32:35], s31 offen
  s_mov_b32 s36, s6
  s_mov_b32 s37, s7
  s_mov_b32 s38, 147456
  s_mov_b32 s39, 0x00020000
  buffer_load_ushort v9, v1, s[36:39], s31 offen
  s_mov_b32 s40, s8
  s_mov_b32 s41, s9
  s_mov_b32 s42, 147456
  s_mov_b32 s43, 0x00020000
  buffer_load_ushort v10, v1, s[40:43], s31 offen
  s_mov_b32 s44, s10
  s_mov_b32 s45, s11
  s_mov_b32 s46, 147456
  s_mov_b32 s47, 0x00020000
  buffer_load_ushort v11, v1, s[44:47], s31 offen
  s_mov_b32 s48, s12
  s_mov_b32 s49, s13
  s_mov_b32 s50, 147456
  s_mov_b32 s51, 0x00020000
  buffer_load_ushort v12, v1, s[48:51], s31 offen
  s_mov_b32 s52, s14
  s_mov_b32 s53, s15
  s_mov_b32 s54, 147456
  s_mov_b32 s55, 0x00020000
  buffer_load_ushort v13, v1, s[52:55], s31 offen
  s_add_u32 s56, s16, 0
  s_addc_u32 s57, s17, 0
  s_mov_b32 s58, 1152
  s_mov_b32 s59, 0x00020000
  s_lshl_b32 s22, s25, 1
  v_mov_b32 v3, s22
  buffer_load_ushort v14, v3, s[56:59], 0 offen
  s_add_u32 s60, s64, 0
  s_addc_u32 s61, s65, 0
  s_mov_b32 s62, 2359296
  s_mov_b32 s63, 0x00020000
  v_lshrrev_b32 v2, 3, v0
  v_mul_u32_u24 v2, 1152, v2
  v_and_b32 v3, 7, v0
  v_lshl_add_u32 v2, v3, 4, v2
  s_lshl_b32 s22, s69, 6
  s_lshl_b32 s23, s28, 4
  s_add_u32 s22, s22, s23
  s_mul_i32 s22, s22, 1152
  s_lshl_b32 s23, s70, 7
  s_add_u32 s22, s22, s23
  s_lshl_b32 s23, s28, 11
  s_add_u32 s23, s23, 61440
  s_mov_b32 m0, s23
  s_nop 0
  buffer_load_dwordx4 v2, s[60:63], s22 offen lds
  s_add_u32 s22, s22, 9216
  s_add_u32 m0, s23, 1024
  s_nop 0
  buffer_load_dwordx4 v2, s[60:63], s22 offen lds
  s_mul_i32 s30, s28, 15360
  v_mul_u32_u24 v84, 240, v0
  v_add_u32 v84, s30, v84
  v_lshrrev_b32 v2, 5, v0
  v_lshrrev_b32 v3, 2, v0
  v_and_b32 v3, 3, v3
  v_lshrrev_b32 v4, 1, v3
  v_lshl_add_u32 v4, v2, 2, v4
  v_mul_u32_u24 v85, 240, v4
  v_add_u32 v85, s30, v85
  v_lshrrev_b32 v4, 4, v0
  v_and_b32 v4, 1, v4
  v_lshlrev_b32 v4, 5, v4
  v_and_b32 v2, 3, v0
  v_lshl_add_u32 v4, v2, 3, v4
  v_add_u32 v85, v85, v4
  v_and_b32 v3, 1, v3
  v_mul_u32_u24 v2, 64, v3
  v_add3_u32 v86, v85, v2, 0
  v_add_u32 v86, 96, v86
  v_mul_u32_u24 v2, 48, v3
  v_add_u32 v85, v85, v2
  v_mov_b32 v120, 0
  v_mov_b32 v121, 0
  v_mov_b32 v122, 0
  v_mov_b32 v123, 0
  v_mov_b32 v124, 0
  v_mov_b32 v125, 0
  v_mov_b32 v126, 0
  v_mov_b32 v127, 0
  v_mov_b32 v128, 0
  v_mov_b32 v129, 0
  v_mov_b32 v130, 0
  v_mov_b32 v131, 0
  v_mov_b32 v132, 0
  v_mov_b32 v133, 0
  v_mov_b32 v134, 0
  v_mov_b32 v135, 0
  s_waitcnt vmcnt(2)
  v_lshlrev_b32 v14, 16, v14
  s_mov_b32 s22, 0x3fb8aa3b
  s_mov_b32 s23, 0x32a57060
  v_mul_f32 v80, s22, v14
  v_fma_f32 v81, v14, s22, -v80
  v_fma_f32 v81, v14, s23, v81
  v_exp_f32 v80, v80
  v_mul_f32 v81, 0x3f317218, v81
  v_fma_f32 v80, v80, v81, v80
  v_cvt_pk_bf16_f32 v80, v80, v80
  v_and_b32 v14, 0xffff0000, v80
  v_lshlrev_b32 v8, 16, v8
  v_lshlrev_b32 v9, 16, v9
  v_lshlrev_b32 v10, 16, v10
  v_lshlrev_b32 v11, 16, v11
  v_lshlrev_b32 v12, 16, v12
  v_lshlrev_b32 v13, 16, v13
  v_mul_f32 v80, v14, v8
  v_mul_f32 v81, v14, v9
  v_mul_f32 v82, 0x3fb8aa3b, v80
  v_mul_f32 v83, 0x3e22f983, v81
  v_mul_f32 v80, 0x3f800000, v82
  v_mul_f32 v81, 0x3f800000, v83
  v_exp_f32 v80, v80
  v_fract_f32 v81, v81
  s_nop 0
  v_cos_f32 v56, v81
  v_sin_f32 v57, v81
  s_nop 0
  v_mul_f32 v56, v56, v80
  v_mul_f32 v57, v57, v80
  v_mul_f32 v80, 0x41000000, v82
  v_mul_f32 v81, 0x41000000, v83
  v_exp_f32 v80, v80
  v_fract_f32 v81, v81
  s_nop 0
  v_cos_f32 v62, v81
  v_sin_f32 v63, v81
  s_nop 0
  v_mul_f32 v62, v62, v80
  v_mul_f32 v63, v63, v80
  v_mul_f32 v80, 0x43800000, v82
  v_mul_f32 v81, 0x43800000, v83
  v_exp_f32 v80, v80
  v_fract_f32 v81, v81
  s_nop 0
  v_cos_f32 v64, v81
  v_sin_f32 v65, v81
  s_nop 0
  v_mul_f32 v64, v64, v80
  v_mul_f32 v65, v65, v80
  v_mul_f32 v68, v14, v10
  v_mul_f32 v69, v14, v11
  v_pk_mul_f32 v[76:77], v[68:69], v[12:13] op_sel_hi:[1,0]
  v_pk_fma_f32 v[66:67], v[68:69], v[12:13], v[76:77] op_sel:[1,1,0] op_sel_hi:[0,1,1] neg_lo:[0,1,0]
  v_pk_mul_f32 v[78:79], v[56:57], v[56:57] op_sel_hi:[1,0]
  v_pk_fma_f32 v[58:59], v[56:57], v[56:57], v[78:79] op_sel:[1,1,0] op_sel_hi:[0,1,1] neg_lo:[0,1,0]
  v_pk_mul_f32 v[76:77], v[58:59], v[58:59] op_sel_hi:[1,0]
  v_pk_fma_f32 v[60:61], v[58:59], v[58:59], v[76:77] op_sel:[1,1,0] op_sel_hi:[0,1,1] neg_lo:[0,1,0]
  v_lshlrev_b32 v2, 4, v0
  s_mul_i32 s22, s27, 3072
  v_add_u32 v2, s22, v2
  global_load_dwordx4 v[24:27], v2, s[20:21] offset:0
  global_load_dwordx4 v[28:31], v2, s[20:21] offset:1024
  global_load_dwordx4 v[32:35], v2, s[20:21] offset:2048
  v_mov_b32 v72, 1.0
  v_mov_b32 v73, 0
  v_cvt_pk_bf16_f32 v96, v72, v62
  v_cvt_pk_bf16_f32 v100, v73, v63
  v_pk_mul_f32 v[78:79], v[62:63], v[62:63] op_sel_hi:[1,0]
  v_pk_fma_f32 v[72:73], v[62:63], v[62:63], v[78:79] op_sel:[1,1,0] op_sel_hi:[0,1,1] neg_lo:[0,1,0]
  v_pk_mul_f32 v[78:79], v[72:73], v[62:63] op_sel_hi:[1,0]
  v_pk_fma_f32 v[74:75], v[72:73], v[62:63], v[78:79] op_sel:[1,1,0] op_sel_hi:[0,1,1] neg_lo:[0,1,0]
  v_cvt_pk_bf16_f32 v97, v72, v74
  v_cvt_pk_bf16_f32 v101, v73, v75
  v_pk_mul_f32 v[76:77], v[66:67], v[56:57] op_sel_hi:[1,0]
  v_pk_fma_f32 v[70:71], v[66:67], v[56:57], v[76:77] op_sel:[1,1,0] op_sel_hi:[0,1,1] neg_lo:[0,1,0]
  v_cvt_pk_bf16_f32 v88, v66, v70
  v_cvt_pk_bf16_f32 v92, -v67, -v71
  v_pk_mul_f32 v[78:79], v[74:75], v[62:63] op_sel_hi:[1,0]
  v_pk_fma_f32 v[72:73], v[74:75], v[62:63], v[78:79] op_sel:[1,1,0] op_sel_hi:[0,1,1] neg_lo:[0,1,0]
  v_pk_mul_f32 v[78:79], v[72:73], v[62:63] op_sel_hi:[1,0]
  v_pk_fma_f32 v[74:75], v[72:73], v[62:63], v[78:79] op_sel:[1,1,0] op_sel_hi:[0,1,1] neg_lo:[0,1,0]
  v_cvt_pk_bf16_f32 v98, v72, v74
  v_cvt_pk_bf16_f32 v102, v73, v75
  v_pk_mul_f32 v[76:77], v[70:71], v[56:57] op_sel_hi:[1,0]
  v_pk_fma_f32 v[68:69], v[70:71], v[56:57], v[76:77] op_sel:[1,1,0] op_sel_hi:[0,1,1] neg_lo:[0,1,0]
  v_pk_mul_f32 v[76:77], v[68:69], v[56:57] op_sel_hi:[1,0]
  v_pk_fma_f32 v[70:71], v[68:69], v[56:57], v[76:77] op_sel:[1,1,0] op_sel_hi:[0,1,1] neg_lo:[0,1,0]
  v_cvt_pk_bf16_f32 v89, v68, v70
  v_cvt_pk_bf16_f32 v93, -v69, -v71
  v_pk_mul_f32 v[78:79], v[74:75], v[62:63] op_sel_hi:[1,0]
  v_pk_fma_f32 v[72:73], v[74:75], v[62:63], v[78:79] op_sel:[1,1,0] op_sel_hi:[0,1,1] neg_lo:[0,1,0]
  v_pk_mul_f32 v[78:79], v[72:73], v[62:63] op_sel_hi:[1,0]
  v_pk_fma_f32 v[74:75], v[72:73], v[62:63], v[78:79] op_sel:[1,1,0] op_sel_hi:[0,1,1] neg_lo:[0,1,0]
  v_cvt_pk_bf16_f32 v99, v72, v74
  v_cvt_pk_bf16_f32 v103, v73, v75
  ds_write_b128 v84, v[96:99] offset:96
  ds_write_b128 v84, v[100:103] offset:160
  v_pk_mul_f32 v[76:77], v[70:71], v[56:57] op_sel_hi:[1,0]
  v_pk_fma_f32 v[68:69], v[70:71], v[56:57], v[76:77] op_sel:[1,1,0] op_sel_hi:[0,1,1] neg_lo:[0,1,0]
  v_pk_mul_f32 v[76:77], v[68:69], v[56:57] op_sel_hi:[1,0]
  v_pk_fma_f32 v[70:71], v[68:69], v[56:57], v[76:77] op_sel:[1,1,0] op_sel_hi:[0,1,1] neg_lo:[0,1,0]
  v_cvt_pk_bf16_f32 v90, v68, v70
  v_cvt_pk_bf16_f32 v94, -v69, -v71
  v_pk_mul_f32 v[78:79], v[74:75], v[62:63] op_sel_hi:[1,0]
  v_pk_fma_f32 v[72:73], v[74:75], v[62:63], v[78:79] op_sel:[1,1,0] op_sel_hi:[0,1,1] neg_lo:[0,1,0]
  v_pk_mul_f32 v[78:79], v[72:73], v[62:63] op_sel_hi:[1,0]
  v_pk_fma_f32 v[74:75], v[72:73], v[62:63], v[78:79] op_sel:[1,1,0] op_sel_hi:[0,1,1] neg_lo:[0,1,0]
  v_cvt_pk_bf16_f32 v96, v72, v74
  v_cvt_pk_bf16_f32 v100, v73, v75
  v_pk_mul_f32 v[76:77], v[70:71], v[56:57] op_sel_hi:[1,0]
  v_pk_fma_f32 v[68:69], v[70:71], v[56:57], v[76:77] op_sel:[1,1,0] op_sel_hi:[0,1,1] neg_lo:[0,1,0]
  v_pk_mul_f32 v[76:77], v[68:69], v[56:57] op_sel_hi:[1,0]
  v_pk_fma_f32 v[70:71], v[68:69], v[56:57], v[76:77] op_sel:[1,1,0] op_sel_hi:[0,1,1] neg_lo:[0,1,0]
  v_cvt_pk_bf16_f32 v91, v68, v70
  v_cvt_pk_bf16_f32 v95, -v69, -v71
  ds_write_b128 v84, v[88:91] offset:0
  ds_write_b128 v84, v[92:95] offset:48
  v_pk_mul_f32 v[78:79], v[74:75], v[62:63] op_sel_hi:[1,0]
  v_pk_fma_f32 v[72:73], v[74:75], v[62:63], v[78:79] op_sel:[1,1,0] op_sel_hi:[0,1,1] neg_lo:[0,1,0]
  v_pk_mul_f32 v[78:79], v[72:73], v[62:63] op_sel_hi:[1,0]
  v_pk_fma_f32 v[74:75], v[72:73], v[62:63], v[78:79] op_sel:[1,1,0] op_sel_hi:[0,1,1] neg_lo:[0,1,0]
  v_cvt_pk_bf16_f32 v97, v72, v74
  v_cvt_pk_bf16_f32 v101, v73, v75
  v_pk_mul_f32 v[76:77], v[66:67], v[64:65] op_sel_hi:[1,0]
  v_pk_fma_f32 v[66:67], v[66:67], v[64:65], v[76:77] op_sel:[1,1,0] op_sel_hi:[0,1,1] neg_lo:[0,1,0]
  v_pk_mul_f32 v[76:77], v[66:67], v[58:59] op_sel_hi:[1,0]
  v_pk_fma_f32 v[70:71], v[66:67], v[58:59], v[76:77] op_sel:[1,1,0] op_sel_hi:[0,1,1] neg_lo:[0,1,0]
  v_cvt_pk_bf16_f32 v88, v66, v70
  v_cvt_pk_bf16_f32 v92, -v67, -v71
  v_pk_mul_f32 v[78:79], v[74:75], v[62:63] op_sel_hi:[1,0]
  v_pk_fma_f32 v[72:73], v[74:75], v[62:63], v[78:79] op_sel:[1,1,0] op_sel_hi:[0,1,1] neg_lo:[0,1,0]
  v_pk_mul_f32 v[78:79], v[72:73], v[62:63] op_sel_hi:[1,0]
  v_pk_fma_f32 v[74:75], v[72:73], v[62:63], v[78:79] op_sel:[1,1,0] op_sel_hi:[0,1,1] neg_lo:[0,1,0]
  v_cvt_pk_bf16_f32 v98, v72, v74
  v_cvt_pk_bf16_f32 v102, v73, v75
  v_pk_mul_f32 v[76:77], v[70:71], v[58:59] op_sel_hi:[1,0]
  v_pk_fma_f32 v[68:69], v[70:71], v[58:59], v[76:77] op_sel:[1,1,0] op_sel_hi:[0,1,1] neg_lo:[0,1,0]
  v_pk_mul_f32 v[76:77], v[68:69], v[58:59] op_sel_hi:[1,0]
  v_pk_fma_f32 v[70:71], v[68:69], v[58:59], v[76:77] op_sel:[1,1,0] op_sel_hi:[0,1,1] neg_lo:[0,1,0]
  v_cvt_pk_bf16_f32 v89, v68, v70
  v_cvt_pk_bf16_f32 v93, -v69, -v71
  v_pk_mul_f32 v[78:79], v[74:75], v[62:63] op_sel_hi:[1,0]
  v_pk_fma_f32 v[72:73], v[74:75], v[62:63], v[78:79] op_sel:[1,1,0] op_sel_hi:[0,1,1] neg_lo:[0,1,0]
  v_pk_mul_f32 v[78:79], v[72:73], v[62:63] op_sel_hi:[1,0]
  v_pk_fma_f32 v[74:75], v[72:73], v[62:63], v[78:79] op_sel:[1,1,0] op_sel_hi:[0,1,1] neg_lo:[0,1,0]
  v_cvt_pk_bf16_f32 v99, v72, v74
  v_cvt_pk_bf16_f32 v103, v73, v75
  ds_write_b128 v84, v[96:99] offset:112
  ds_write_b128 v84, v[100:103] offset:176
  v_pk_mul_f32 v[76:77], v[66:67], v[64:65] op_sel_hi:[1,0]
  v_pk_fma_f32 v[66:67], v[66:67], v[64:65], v[76:77] op_sel:[1,1,0] op_sel_hi:[0,1,1] neg_lo:[0,1,0]
  v_pk_mul_f32 v[76:77], v[66:67], v[60:61] op_sel_hi:[1,0]
  v_pk_fma_f32 v[70:71], v[66:67], v[60:61], v[76:77] op_sel:[1,1,0] op_sel_hi:[0,1,1] neg_lo:[0,1,0]
  v_cvt_pk_bf16_f32 v90, v66, v70
  v_cvt_pk_bf16_f32 v94, -v67, -v71
  v_pk_mul_f32 v[78:79], v[74:75], v[62:63] op_sel_hi:[1,0]
  v_pk_fma_f32 v[72:73], v[74:75], v[62:63], v[78:79] op_sel:[1,1,0] op_sel_hi:[0,1,1] neg_lo:[0,1,0]
  v_pk_mul_f32 v[78:79], v[72:73], v[62:63] op_sel_hi:[1,0]
  v_pk_fma_f32 v[74:75], v[72:73], v[62:63], v[78:79] op_sel:[1,1,0] op_sel_hi:[0,1,1] neg_lo:[0,1,0]
  v_cvt_pk_bf16_f32 v96, v72, v74
  v_cvt_pk_bf16_f32 v100, v73, v75
  v_pk_mul_f32 v[76:77], v[66:67], v[64:65] op_sel_hi:[1,0]
  v_pk_fma_f32 v[66:67], v[66:67], v[64:65], v[76:77] op_sel:[1,1,0] op_sel_hi:[0,1,1] neg_lo:[0,1,0]
  v_pk_mul_f32 v[76:77], v[66:67], v[60:61] op_sel_hi:[1,0]
  v_pk_fma_f32 v[70:71], v[66:67], v[60:61], v[76:77] op_sel:[1,1,0] op_sel_hi:[0,1,1] neg_lo:[0,1,0]
  v_cvt_pk_bf16_f32 v91, v66, v70
  v_cvt_pk_bf16_f32 v95, -v67, -v71
  ds_write_b128 v84, v[88:91] offset:16
  ds_write_b128 v84, v[92:95] offset:64
  v_pk_mul_f32 v[78:79], v[74:75], v[62:63] op_sel_hi:[1,0]
  v_pk_fma_f32 v[72:73], v[74:75], v[62:63], v[78:79] op_sel:[1,1,0] op_sel_hi:[0,1,1] neg_lo:[0,1,0]
  v_pk_mul_f32 v[78:79], v[72:73], v[62:63] op_sel_hi:[1,0]
  v_pk_fma_f32 v[74:75], v[72:73], v[62:63], v[78:79] op_sel:[1,1,0] op_sel_hi:[0,1,1] neg_lo:[0,1,0]
  v_cvt_pk_bf16_f32 v97, v72, v74
  v_cvt_pk_bf16_f32 v101, v73, v75
  v_pk_mul_f32 v[76:77], v[66:67], v[64:65] op_sel_hi:[1,0]
  v_pk_fma_f32 v[68:69], v[66:67], v[64:65], v[76:77] op_sel:[1,1,0] op_sel_hi:[0,1,1] neg_lo:[0,1,0]
  v_pk_mul_f32 v[76:77], v[68:69], v[64:65] op_sel_hi:[1,0]
  v_pk_fma_f32 v[70:71], v[68:69], v[64:65], v[76:77] op_sel:[1,1,0] op_sel_hi:[0,1,1] neg_lo:[0,1,0]
  v_cvt_pk_bf16_f32 v88, v68, v70
  v_cvt_pk_bf16_f32 v92, -v69, -v71
  v_pk_mul_f32 v[78:79], v[74:75], v[62:63] op_sel_hi:[1,0]
  v_pk_fma_f32 v[72:73], v[74:75], v[62:63], v[78:79] op_sel:[1,1,0] op_sel_hi:[0,1,1] neg_lo:[0,1,0]
  v_pk_mul_f32 v[78:79], v[72:73], v[62:63] op_sel_hi:[1,0]
  v_pk_fma_f32 v[74:75], v[72:73], v[62:63], v[78:79] op_sel:[1,1,0] op_sel_hi:[0,1,1] neg_lo:[0,1,0]
  v_cvt_pk_bf16_f32 v98, v72, v74
  v_cvt_pk_bf16_f32 v102, v73, v75
  v_pk_mul_f32 v[76:77], v[70:71], v[64:65] op_sel_hi:[1,0]
  v_pk_fma_f32 v[68:69], v[70:71], v[64:65], v[76:77] op_sel:[1,1,0] op_sel_hi:[0,1,1] neg_lo:[0,1,0]
  v_pk_mul_f32 v[76:77], v[68:69], v[64:65] op_sel_hi:[1,0]
  v_pk_fma_f32 v[70:71], v[68:69], v[64:65], v[76:77] op_sel:[1,1,0] op_sel_hi:[0,1,1] neg_lo:[0,1,0]
  v_cvt_pk_bf16_f32 v89, v68, v70
  v_cvt_pk_bf16_f32 v93, -v69, -v71
  v_pk_mul_f32 v[78:79], v[74:75], v[62:63] op_sel_hi:[1,0]
  v_pk_fma_f32 v[72:73], v[74:75], v[62:63], v[78:79] op_sel:[1,1,0] op_sel_hi:[0,1,1] neg_lo:[0,1,0]
  v_pk_mul_f32 v[78:79], v[72:73], v[62:63] op_sel_hi:[1,0]
  v_pk_fma_f32 v[74:75], v[72:73], v[62:63], v[78:79] op_sel:[1,1,0] op_sel_hi:[0,1,1] neg_lo:[0,1,0]
  v_cvt_pk_bf16_f32 v99, v72, v74
  v_cvt_pk_bf16_f32 v103, v73, v75
  ds_write_b128 v84, v[96:99] offset:128
  ds_write_b128 v84, v[100:103] offset:192
  v_pk_mul_f32 v[76:77], v[70:71], v[64:65] op_sel_hi:[1,0]
  v_pk_fma_f32 v[68:69], v[70:71], v[64:65], v[76:77] op_sel:[1,1,0] op_sel_hi:[0,1,1] neg_lo:[0,1,0]
  v_cvt_pk_bf16_f32 v90, v68, v68
  v_cvt_pk_bf16_f32 v94, -v69, -v69
  v_cvt_pk_bf16_f32 v91, v68, v68
  v_cvt_pk_bf16_f32 v95, -v69, -v69
  ds_write_b128 v84, v[88:91] offset:32
  ds_write_b128 v84, v[92:95] offset:80
  v_pk_mul_f32 v[78:79], v[74:75], v[62:63] op_sel_hi:[1,0]
  v_pk_fma_f32 v[72:73], v[74:75], v[62:63], v[78:79] op_sel:[1,1,0] op_sel_hi:[0,1,1] neg_lo:[0,1,0]
  v_pk_mul_f32 v[78:79], v[72:73], v[62:63] op_sel_hi:[1,0]
  v_pk_fma_f32 v[74:75], v[72:73], v[62:63], v[78:79] op_sel:[1,1,0] op_sel_hi:[0,1,1] neg_lo:[0,1,0]
  v_cvt_pk_bf16_f32 v96, v72, v74
  v_cvt_pk_bf16_f32 v100, v73, v75
  v_pk_mul_f32 v[78:79], v[74:75], v[62:63] op_sel_hi:[1,0]
  v_pk_fma_f32 v[72:73], v[74:75], v[62:63], v[78:79] op_sel:[1,1,0] op_sel_hi:[0,1,1] neg_lo:[0,1,0]
  v_pk_mul_f32 v[78:79], v[72:73], v[62:63] op_sel_hi:[1,0]
  v_pk_fma_f32 v[74:75], v[72:73], v[62:63], v[78:79] op_sel:[1,1,0] op_sel_hi:[0,1,1] neg_lo:[0,1,0]
  v_cvt_pk_bf16_f32 v97, v72, v74
  v_cvt_pk_bf16_f32 v101, v73, v75
  v_pk_mul_f32 v[78:79], v[74:75], v[62:63] op_sel_hi:[1,0]
  v_pk_fma_f32 v[72:73], v[74:75], v[62:63], v[78:79] op_sel:[1,1,0] op_sel_hi:[0,1,1] neg_lo:[0,1,0]
  v_pk_mul_f32 v[78:79], v[72:73], v[62:63] op_sel_hi:[1,0]
  v_pk_fma_f32 v[74:75], v[72:73], v[62:63], v[78:79] op_sel:[1,1,0] op_sel_hi:[0,1,1] neg_lo:[0,1,0]
  v_cvt_pk_bf16_f32 v98, v72, v74
  v_cvt_pk_bf16_f32 v102, v73, v75
  v_pk_mul_f32 v[78:79], v[74:75], v[62:63] op_sel_hi:[1,0]
  v_pk_fma_f32 v[72:73], v[74:75], v[62:63], v[78:79] op_sel:[1,1,0] op_sel_hi:[0,1,1] neg_lo:[0,1,0]
  v_pk_mul_f32 v[78:79], v[72:73], v[62:63] op_sel_hi:[1,0]
  v_pk_fma_f32 v[74:75], v[72:73], v[62:63], v[78:79] op_sel:[1,1,0] op_sel_hi:[0,1,1] neg_lo:[0,1,0]
  v_cvt_pk_bf16_f32 v99, v72, v74
  v_cvt_pk_bf16_f32 v103, v73, v75
  ds_write_b128 v84, v[96:99] offset:144
  ds_write_b128 v84, v[100:103] offset:208
  s_waitcnt lgkmcnt(0)
  ds_read_b64_tr_b16 v[104:105], v85 offset:0
  ds_read_b64_tr_b16 v[108:109], v86 offset:0
  ds_read_b64_tr_b16 v[106:107], v85 offset:480
  ds_read_b64_tr_b16 v[110:111], v86 offset:480
  ds_read_b64_tr_b16 v[112:113], v85 offset:1920
  ds_read_b64_tr_b16 v[116:117], v86 offset:1920
  ds_read_b64_tr_b16 v[114:115], v85 offset:2400
  ds_read_b64_tr_b16 v[118:119], v86 offset:2400
  s_waitcnt lgkmcnt(4)
  v_mfma_f32_32x32x16_bf16 v[120:135], v[104:107], v[108:111], v[120:135]
  ds_read_b64_tr_b16 v[104:105], v85 offset:3840
  ds_read_b64_tr_b16 v[108:109], v86 offset:3840
  ds_read_b64_tr_b16 v[106:107], v85 offset:4320
  ds_read_b64_tr_b16 v[110:111], v86 offset:4320
  s_waitcnt lgkmcnt(4)
  v_mfma_f32_32x32x16_bf16 v[120:135], v[112:115], v[116:119], v[120:135]
  ds_read_b64_tr_b16 v[112:113], v85 offset:5760
  ds_read_b64_tr_b16 v[116:117], v86 offset:5760
  ds_read_b64_tr_b16 v[114:115], v85 offset:6240
  ds_read_b64_tr_b16 v[118:119], v86 offset:6240
  s_waitcnt lgkmcnt(4)
  v_mfma_f32_32x32x16_bf16 v[120:135], v[104:107], v[108:111], v[120:135]
  ds_read_b64_tr_b16 v[104:105], v85 offset:7680
  ds_read_b64_tr_b16 v[108:109], v86 offset:7680
  ds_read_b64_tr_b16 v[106:107], v85 offset:8160
  ds_read_b64_tr_b16 v[110:111], v86 offset:8160
  s_waitcnt lgkmcnt(4)
  v_mfma_f32_32x32x16_bf16 v[120:135], v[112:115], v[116:119], v[120:135]
  ds_read_b64_tr_b16 v[112:113], v85 offset:9600
  ds_read_b64_tr_b16 v[116:117], v86 offset:9600
  ds_read_b64_tr_b16 v[114:115], v85 offset:10080
  ds_read_b64_tr_b16 v[118:119], v86 offset:10080
  s_waitcnt lgkmcnt(4)
  v_mfma_f32_32x32x16_bf16 v[120:135], v[104:107], v[108:111], v[120:135]
  ds_read_b64_tr_b16 v[104:105], v85 offset:11520
  ds_read_b64_tr_b16 v[108:109], v86 offset:11520
  ds_read_b64_tr_b16 v[106:107], v85 offset:12000
  ds_read_b64_tr_b16 v[110:111], v86 offset:12000
  s_waitcnt lgkmcnt(4)
  v_mfma_f32_32x32x16_bf16 v[120:135], v[112:115], v[116:119], v[120:135]
  ds_read_b64_tr_b16 v[112:113], v85 offset:13440
  ds_read_b64_tr_b16 v[116:117], v86 offset:13440
  ds_read_b64_tr_b16 v[114:115], v85 offset:13920
  ds_read_b64_tr_b16 v[118:119], v86 offset:13920
  s_waitcnt lgkmcnt(4)
  v_mfma_f32_32x32x16_bf16 v[120:135], v[104:107], v[108:111], v[120:135]
  s_waitcnt lgkmcnt(0)
  v_mfma_f32_32x32x16_bf16 v[120:135], v[112:115], v[116:119], v[120:135]
  v_lshlrev_b32 v2, 4, v0
  s_mul_i32 s22, s26, 30720
  s_add_u32 s22, s22, 15360
  v_add_u32 v2, s22, v2
  s_waitcnt vmcnt(3)
  s_nop 7
  s_cmp_eq_u32 s27, 0
  s_cbranch_scc1 l1k_c0
  ds_write_b128 v2, v[120:123] offset:0
  ds_write_b128 v2, v[124:127] offset:1024
  ds_write_b128 v2, v[128:131] offset:2048
  s_waitcnt lgkmcnt(0)
  s_barrier
  s_branch l1k_c1
l1k_c0:
  s_barrier
  ds_read_b128 v[104:107], v2 offset:0
  ds_read_b128 v[108:111], v2 offset:1024
  ds_read_b128 v[112:115], v2 offset:2048
  v_and_b32 v3, 31, v0
  v_lshrrev_b32 v4, 5, v0
  v_lshlrev_b32 v3, 1, v3
  v_lshl_add_u32 v3, v4, 8, v3
  s_lshl_b32 s22, s26, 11
  s_add_u32 s22, s22, 69632
  v_add_u32 v3, s22, v3
  v_mov_b32 v4, s22
  v_mov_b32 v80, 0
  ds_write_b32 v4, v80 offset:1536
  s_waitcnt lgkmcnt(1)
  v_add_f32 v120, v120, v104
  v_add_f32 v121, v121, v105
  v_add_f32 v122, v122, v106
  v_add_f32 v123, v123, v107
  v_cvt_pk_bf16_f32 v80, v120, v121
  v_cvt_pk_bf16_f32 v81, v122, v123
  ds_write_b16 v3, v80 offset:0
  ds_write_b16_d16_hi v3, v80 offset:64
  ds_write_b16 v3, v81 offset:128
  ds_write_b16_d16_hi v3, v81 offset:192
  v_add_f32 v124, v124, v108
  v_add_f32 v125, v125, v109
  v_add_f32 v126, v126, v110
  v_add_f32 v127, v127, v111
  v_cvt_pk_bf16_f32 v80, v124, v125
  v_cvt_pk_bf16_f32 v81, v126, v127
  ds_write_b16 v3, v80 offset:512
  ds_write_b16_d16_hi v3, v80 offset:576
  ds_write_b16 v3, v81 offset:640
  ds_write_b16_d16_hi v3, v81 offset:704
  v_add_f32 v128, v128, v112
  v_add_f32 v129, v129, v113
  v_add_f32 v130, v130, v114
  v_add_f32 v131, v131, v115
  v_cvt_pk_bf16_f32 v80, v128, v129
  v_cvt_pk_bf16_f32 v81, v130, v131
  ds_write_b16 v3, v80 offset:1024
  ds_write_b16_d16_hi v3, v80 offset:1088
  ds_write_b16 v3, v81 offset:1152
  ds_write_b16_d16_hi v3, v81 offset:1216
l1k_c1:
  v_lshrrev_b32 v2, 4, v0
  v_lshrrev_b32 v3, 2, v0
  v_and_b32 v3, 3, v3
  v_lshl_add_u32 v3, v2, 3, v3
  v_lshlrev_b32 v3, 7, v3
  v_and_b32 v4, 3, v0
  v_lshl_add_u32 v3, v4, 3, v3
  s_lshl_b32 s22, s28, 5
  s_add_u32 s22, s22, 61440
  v_add_u32 v3, s22, v3
  ds_read_b64_tr_b16 v[16:17], v3 offset:0
  ds_read_b64_tr_b16 v[18:19], v3 offset:512
  ds_read_b64_tr_b16 v[20:21], v3 offset:4096
  ds_read_b64_tr_b16 v[22:23], v3 offset:4608
  v_and_b32 v4, 15, v0
  v_mul_u32_u24 v4, 4608, v4
  v_lshl_add_u32 v4, v2, 4, v4
  s_add_u32 s72, s18, 11927552
  s_addc_u32 s73, s19, 0
  s_mov_b32 s74, 2654208
  s_mov_b32 s75, 0x00020000
  s_lshl_b32 s22, s70, 6
  s_lshl_b32 s23, s28, 4
  s_add_u32 s22, s22, s23
  s_mul_i32 s22, s22, 4608
  s_lshl_b32 s23, s69, 7
  s_add_u32 s23, s23, s22
  s_add_u32 s23, s23, 512
  s_waitcnt lgkmcnt(0)
  buffer_store_dwordx4 v[16:19], v4, s[72:75], s23 offen
  buffer_store_dwordx4 v[20:23], v4, s[72:75], s23 offen offset:64
  s_cmp_ge_u32 s69, 4
  s_cbranch_scc1 l1k_nz
  v_lshrrev_b32 v2, 3, v0
  v_mul_u32_u24 v2, 4608, v2
  v_and_b32 v3, 7, v0
  v_lshl_add_u32 v2, v3, 4, v2
  s_lshl_b32 s23, s69, 7
  s_add_u32 s22, s22, s23
  v_mov_b32 v80, 0
  v_mov_b32 v81, 0
  v_mov_b32 v82, 0
  v_mov_b32 v83, 0
  buffer_store_dwordx4 v[80:83], v2, s[72:75], s22 offen
  s_add_u32 s22, s22, 36864
  buffer_store_dwordx4 v[80:83], v2, s[72:75], s22 offen
l1k_nz:
  s_waitcnt lgkmcnt(0)
  s_barrier
  s_lshl_b32 s22, s26, 11
  s_add_u32 s22, s22, 69632
  v_mov_b32 v4, s22
  s_mul_i32 s31, s25, 4224
  s_add_u32 s31, s31, 14581760
  s_add_u32 s56, s18, s31
  s_addc_u32 s57, s19, 0
  s_mov_b32 s58, 4224
  s_mov_b32 s59, 0x00020000
  s_mul_i32 s22, s27, 3072
  v_lshlrev_b32 v2, 4, v0
  s_waitcnt vmcnt(2)
  v_add_u32_sdwa v56, v4, v24 dst_sel:DWORD dst_unused:UNUSED_PAD src0_sel:DWORD src1_sel:WORD_0
  v_add_u32_sdwa v57, v4, v24 dst_sel:DWORD dst_unused:UNUSED_PAD src0_sel:DWORD src1_sel:WORD_1
  v_add_u32_sdwa v58, v4, v25 dst_sel:DWORD dst_unused:UNUSED_PAD src0_sel:DWORD src1_sel:WORD_0
  v_add_u32_sdwa v59, v4, v25 dst_sel:DWORD dst_unused:UNUSED_PAD src0_sel:DWORD src1_sel:WORD_1
  v_add_u32_sdwa v60, v4, v26 dst_sel:DWORD dst_unused:UNUSED_PAD src0_sel:DWORD src1_sel:WORD_0
  v_add_u32_sdwa v61, v4, v26 dst_sel:DWORD dst_unused:UNUSED_PAD src0_sel:DWORD src1_sel:WORD_1
  v_add_u32_sdwa v62, v4, v27 dst_sel:DWORD dst_unused:UNUSED_PAD src0_sel:DWORD src1_sel:WORD_0
  v_add_u32_sdwa v63, v4, v27 dst_sel:DWORD dst_unused:UNUSED_PAD src0_sel:DWORD src1_sel:WORD_1
  ds_read_u16 v56, v56
  ds_read_u16 v57, v57
  ds_read_u16 v58, v58
  ds_read_u16 v59, v59
  ds_read_u16 v60, v60
  ds_read_u16 v61, v61
  ds_read_u16 v62, v62
  ds_read_u16 v63, v63
  v_add_u32_sdwa v64, v4, v28 dst_sel:DWORD dst_unused:UNUSED_PAD src0_sel:DWORD src1_sel:WORD_0
  v_add_u32_sdwa v65, v4, v28 dst_sel:DWORD dst_unused:UNUSED_PAD src0_sel:DWORD src1_sel:WORD_1
  v_add_u32_sdwa v66, v4, v29 dst_sel:DWORD dst_unused:UNUSED_PAD src0_sel:DWORD src1_sel:WORD_0
  v_add_u32_sdwa v67, v4, v29 dst_sel:DWORD dst_unused:UNUSED_PAD src0_sel:DWORD src1_sel:WORD_1
  v_add_u32_sdwa v68, v4, v30 dst_sel:DWORD dst_unused:UNUSED_PAD src0_sel:DWORD src1_sel:WORD_0
  v_add_u32_sdwa v69, v4, v30 dst_sel:DWORD dst_unused:UNUSED_PAD src0_sel:DWORD src1_sel:WORD_1
  v_add_u32_sdwa v70, v4, v31 dst_sel:DWORD dst_unused:UNUSED_PAD src0_sel:DWORD src1_sel:WORD_0
  v_add_u32_sdwa v71, v4, v31 dst_sel:DWORD dst_unused:UNUSED_PAD src0_sel:DWORD src1_sel:WORD_1
  ds_read_u16 v64, v64
  ds_read_u16 v65, v65
  ds_read_u16 v66, v66
  ds_read_u16 v67, v67
  ds_read_u16 v68, v68
  ds_read_u16 v69, v69
  ds_read_u16 v70, v70
  ds_read_u16 v71, v71
  s_waitcnt lgkmcnt(8)
  v_lshl_or_b32 v72, v57, 16, v56
  v_lshl_or_b32 v73, v59, 16, v58
  v_lshl_or_b32 v74, v61, 16, v60
  v_lshl_or_b32 v75, v63, 16, v62
  buffer_store_dwordx4 v[72:75], v2, s[56:59], s22 offen offset:0
  v_add_u32_sdwa v56, v4, v32 dst_sel:DWORD dst_unused:UNUSED_PAD src0_sel:DWORD src1_sel:WORD_0
  v_add_u32_sdwa v57, v4, v32 dst_sel:DWORD dst_unused:UNUSED_PAD src0_sel:DWORD src1_sel:WORD_1
  v_add_u32_sdwa v58, v4, v33 dst_sel:DWORD dst_unused:UNUSED_PAD src0_sel:DWORD src1_sel:WORD_0
  v_add_u32_sdwa v59, v4, v33 dst_sel:DWORD dst_unused:UNUSED_PAD src0_sel:DWORD src1_sel:WORD_1
  v_add_u32_sdwa v60, v4, v34 dst_sel:DWORD dst_unused:UNUSED_PAD src0_sel:DWORD src1_sel:WORD_0
  v_add_u32_sdwa v61, v4, v34 dst_sel:DWORD dst_unused:UNUSED_PAD src0_sel:DWORD src1_sel:WORD_1
  v_add_u32_sdwa v62, v4, v35 dst_sel:DWORD dst_unused:UNUSED_PAD src0_sel:DWORD src1_sel:WORD_0
  v_add_u32_sdwa v63, v4, v35 dst_sel:DWORD dst_unused:UNUSED_PAD src0_sel:DWORD src1_sel:WORD_1
  ds_read_u16 v56, v56
  ds_read_u16 v57, v57
  ds_read_u16 v58, v58
  ds_read_u16 v59, v59
  ds_read_u16 v60, v60
  ds_read_u16 v61, v61
  ds_read_u16 v62, v62
  ds_read_u16 v63, v63
  s_waitcnt lgkmcnt(8)
  v_lshl_or_b32 v76, v65, 16, v64
  v_lshl_or_b32 v77, v67, 16, v66
  v_lshl_or_b32 v78, v69, 16, v68
  v_lshl_or_b32 v79, v71, 16, v70
  buffer_store_dwordx4 v[76:79], v2, s[56:59], s22 offen offset:1024
  s_waitcnt lgkmcnt(0)
  v_lshl_or_b32 v72, v57, 16, v56
  v_lshl_or_b32 v73, v59, 16, v58
  v_lshl_or_b32 v74, v61, 16, v60
  v_lshl_or_b32 v75, v63, 16, v62
  buffer_store_dwordx4 v[72:75], v2, s[56:59], s22 offen offset:2048
  s_endpgm
l1_pf:
  s_getpc_b64 s[4:5]
l1_pf_pc:
  s_sub_u32 s4, s4, l1_pf_pc-l1_kernel
  s_subb_u32 s5, s5, 0
  v_lshlrev_b32 v1, 7, v0
  s_mov_b32 s6, text_end-l1_kernel
  s_mov_b32 s7, 0x00020000
  s_mov_b32 s8, s4
  s_mov_b32 s9, s5
  s_mov_b32 s10, s6
  s_mov_b32 s11, 0x00020000
  buffer_load_dword v2, v1, s[8:11], 0 offen
  s_mov_b32 s12, 32768
  buffer_load_dword v3, v1, s[8:11], s12 offen
  s_waitcnt vmcnt(0)
l1_kernel_end:
  s_endpgm
.p2align 4
.type l1_idxtab,@object
l1_idxtab:
  .short 1536, 1280, 1280, 1280, 1280, 1278, 1278, 1278, 1278, 1278, 1278, 1278, 1276, 1276, 1276, 1276
  .short 1276, 1276, 1276, 1276, 1276, 1274, 1274, 1274, 1274, 1274, 1274, 1274, 1272, 1272, 1272, 1272
  .short 1272, 1272, 1272, 1272, 1272, 1270, 1270, 1270, 1270, 1270, 1270, 1270, 1268, 1268, 1268, 1268
  .short 1268, 1268, 1268, 1268, 1268, 1266, 1266, 1266, 1266, 1266, 1266, 1266, 1264, 1264, 1264, 1264
  .short 1264, 1264, 1264, 1264, 1264, 1262, 1262, 1262, 1262, 1262, 1262, 1262, 1260, 1260, 1260, 1260
  .short 1260, 1260, 1260, 1260, 1260, 1258, 1258, 1258, 1258, 1258, 1258, 1258, 1256, 1256, 1256, 1256
  .short 1256, 1256, 1256, 1256, 1256, 1254, 1254, 1254, 1254, 1254, 1254, 1254, 1252, 1252, 1252, 1252
  .short 1252, 1252, 1252, 1252, 1252, 1250, 1250, 1250, 1250, 1250, 1250, 1250, 1248, 1248, 1248, 1248
  .short 1248, 1248, 1248, 1248, 1248, 1246, 1246, 1246, 1246, 1246, 1246, 1246, 1244, 1244, 1244, 1244
  .short 1244, 1244, 1244, 1244, 1244, 1242, 1242, 1242, 1242, 1242, 1242, 1242, 1240, 1240, 1240, 1240
  .short 1240, 1240, 1240, 1240, 1240, 1238, 1238, 1238, 1238, 1238, 1238, 1238, 1236, 1236, 1236, 1236
  .short 1236, 1236, 1236, 1236, 1236, 1234, 1234, 1234, 1234, 1234, 1234, 1234, 1232, 1232, 1232, 1232
  .short 1232, 1232, 1232, 1232, 1232, 1230, 1230, 1230, 1230, 1230, 1230, 1230, 1228, 1228, 1228, 1228
  .short 1228, 1228, 1228, 1228, 1228, 1226, 1226, 1226, 1226, 1226, 1226, 1226, 1224, 1224, 1224, 1224
  .short 1224, 1224, 1224, 1224, 1224, 1222, 1222, 1222, 1222, 1222, 1222, 1222, 1220, 1220, 1220, 1220
  .short 1220, 1220, 1220, 1220, 1220, 1218, 1218, 1218, 1218, 1218, 1218, 1218, 1216, 1216, 1216, 1216
  .short 1216, 1216, 1216, 1216, 1216, 1214, 1214, 1214, 1214, 1214, 1214, 1214, 1212, 1212, 1212, 1212
  .short 1212, 1212, 1212, 1212, 1212, 1210, 1210, 1210, 1210, 1210, 1210, 1210, 1208, 1208, 1208, 1208
  .short 1208, 1208, 1208, 1208, 1208, 1206, 1206, 1206, 1206, 1206, 1206, 1206, 1204, 1204, 1204, 1204
  .short 1204, 1204, 1204, 1204, 1204, 1202, 1202, 1202, 1202, 1202, 1202, 1202, 1200, 1200, 1200, 1200
  .short 1200, 1200, 1200, 1200, 1200, 1198, 1198, 1198, 1198, 1198, 1198, 1198, 1196, 1196, 1196, 1196
  .short 1196, 1196, 1196, 1196, 1196, 1194, 1194, 1194, 1194, 1194, 1194, 1194, 1192, 1192, 1192, 1192
  .short 1192, 1192, 1192, 1192, 1192, 1190, 1190, 1190, 1190, 1190, 1190, 1190, 1188, 1188, 1188, 1188
  .short 1188, 1188, 1188, 1188, 1188, 1186, 1186, 1186, 1186, 1186, 1186, 1186, 1184, 1184, 1184, 1184
  .short 1184, 1184, 1184, 1184, 1184, 1182, 1182, 1182, 1182, 1182, 1182, 1182, 1180, 1180, 1180, 1180
  .short 1180, 1180, 1180, 1180, 1180, 1178, 1178, 1178, 1178, 1178, 1178, 1178, 1176, 1176, 1176, 1176
  .short 1176, 1176, 1176, 1176, 1176, 1174, 1174, 1174, 1174, 1174, 1174, 1174, 1172, 1172, 1172, 1172
  .short 1172, 1172, 1172, 1172, 1172, 1170, 1170, 1170, 1170, 1170, 1170, 1170, 1168, 1168, 1168, 1168
  .short 1168, 1168, 1168, 1168, 1168, 1166, 1166, 1166, 1166, 1166, 1166, 1166, 1164, 1164, 1164, 1164
  .short 1164, 1164, 1164, 1164, 1164, 1162, 1162, 1162, 1162, 1162, 1162, 1162, 1160, 1160, 1160, 1160
  .short 1160, 1160, 1160, 1160, 1160, 1158, 1158, 1158, 1158, 1158, 1158, 1158, 1156, 1156, 1156, 1156
  .short 1156, 1156, 1156, 1156, 1156, 1154, 1154, 1154, 1154, 1154, 1154, 1154, 1152, 1152, 1152, 1152
  .short 1152, 1152, 1152, 1152, 1152, 1150, 1150, 1150, 1150, 1150, 1150, 1150, 1148, 1148, 1148, 1148
  .short 1148, 1148, 1148, 1148, 1148, 1146, 1146, 1146, 1146, 1146, 1146, 1146, 1144, 1144, 1144, 1144
  .short 1144, 1144, 1144, 1144, 1144, 1142, 1142, 1142, 1142, 1142, 1142, 1142, 1140, 1140, 1140, 1140
  .short 1140, 1140, 1140, 1140, 1140, 1138, 1138, 1138, 1138, 1138, 1138, 1138, 1136, 1136, 1136, 1136
  .short 1136, 1136, 1136, 1136, 1136, 1134, 1134, 1134, 1134, 1134, 1134, 1134, 1132, 1132, 1132, 1132
  .short 1132, 1132, 1132, 1132, 1132, 1130, 1130, 1130, 1130, 1130, 1130, 1130, 1128, 1128, 1128, 1128
  .short 1128, 1128, 1128, 1128, 1128, 1126, 1126, 1126, 1126, 1126, 1126, 1126, 1124, 1124, 1124, 1124
  .short 1124, 1124, 1124, 1124, 1124, 1122, 1122, 1122, 1122, 1122, 1122, 1122, 1120, 1120, 1120, 1120
  .short 1120, 1120, 1120, 1120, 1120, 1118, 1118, 1118, 1118, 1118, 1118, 1118, 1116, 1116, 1116, 1116
  .short 1116, 1116, 1116, 1116, 1116, 1114, 1114, 1114, 1114, 1114, 1114, 1114, 1112, 1112, 1112, 1112
  .short 1112, 1112, 1112, 1112, 1112, 1110, 1110, 1110, 1110, 1110, 1110, 1110, 1108, 1108, 1108, 1108
  .short 1108, 1108, 1108, 1108, 1108, 1106, 1106, 1106, 1106, 1106, 1106, 1106, 1104, 1104, 1104, 1104
  .short 1104, 1104, 1104, 1104, 1104, 1102, 1102, 1102, 1102, 1102, 1102, 1102, 1100, 1100, 1100, 1100
  .short 1100, 1100, 1100, 1100, 1100, 1098, 1098, 1098, 1098, 1098, 1098, 1098, 1096, 1096, 1096, 1096
  .short 1096, 1096, 1096, 1096, 1096, 1094, 1094, 1094, 1094, 1094, 1094, 1094, 1092, 1092, 1092, 1092
  .short 1092, 1092, 1092, 1092, 1092, 1090, 1090, 1090, 1090, 1090, 1090, 1090, 1088, 1088, 1088, 1088
  .short 1088, 1088, 1088, 1088, 1088, 1086, 1086, 1086, 1086, 1086, 1086, 1086, 1084, 1084, 1084, 1084
  .short 1084, 1084, 1084, 1084, 1084, 1082, 1082, 1082, 1082, 1082, 1082, 1082, 1080, 1080, 1080, 1080
  .short 1080, 1080, 1080, 1080, 1080, 1078, 1078, 1078, 1078, 1078, 1078, 1078, 1076, 1076, 1076, 1076
  .short 1076, 1076, 1076, 1076, 1076, 1074, 1074, 1074, 1074, 1074, 1074, 1074, 1072, 1072, 1072, 1072
  .short 1072, 1072, 1072, 1072, 1072, 1070, 1070, 1070, 1070, 1070, 1070, 1070, 1068, 1068, 1068, 1068
  .short 1068, 1068, 1068, 1068, 1068, 1066, 1066, 1066, 1066, 1066, 1066, 1066, 1064, 1064, 1064, 1064
  .short 1064, 1064, 1064, 1064, 1064, 1062, 1062, 1062, 1062, 1062, 1062, 1062, 1060, 1060, 1060, 1060
  .short 1060, 1060, 1060, 1060, 1060, 1058, 1058, 1058, 1058, 1058, 1058, 1058, 1056, 1056, 1056, 1056
  .short 1056, 1056, 1056, 1056, 1056, 1054, 1054, 1054, 1054, 1054, 1054, 1054, 1052, 1052, 1052, 1052
  .short 1052, 1052, 1052, 1052, 1052, 1050, 1050, 1050, 1050, 1050, 1050, 1050, 1048, 1048, 1048, 1048
  .short 1048, 1048, 1048, 1048, 1048, 1046, 1046, 1046, 1046, 1046, 1046, 1046, 1044, 1044, 1044, 1044
  .short 1044, 1044, 1044, 1044, 1044, 1042, 1042, 1042, 1042, 1042, 1042, 1042, 1040, 1040, 1040, 1040
  .short 1040, 1040, 1040, 1040, 1040, 1038, 1038, 1038, 1038, 1038, 1038, 1038, 1036, 1036, 1036, 1036
  .short 1036, 1036, 1036, 1036, 1036, 1034, 1034, 1034, 1034, 1034, 1034, 1034, 1032, 1032, 1032, 1032
  .short 1032, 1032, 1032, 1032, 1032, 1030, 1030, 1030, 1030, 1030, 1030, 1030, 1028, 1028, 1028, 1028
  .short 1028, 1028, 1028, 1028, 1028, 1026, 1026, 1026, 1026, 1026, 1026, 1026, 1024, 1024, 1024, 1024
  .short 1024, 1024, 1024, 1022, 1022, 1022, 958, 958, 958, 958, 958, 1020, 1020, 1020, 956, 956
  .short 956, 956, 956, 1018, 1018, 1018, 954, 954, 954, 954, 954, 1016, 1016, 1016, 952, 952
  .short 952, 952, 952, 1014, 1014, 1014, 950, 950, 950, 950, 950, 1012, 1012, 1012, 948, 948
  .short 948, 948, 948, 1010, 1010, 1010, 946, 946, 946, 946, 946, 1008, 1008, 1008, 944, 944
  .short 944, 944, 944, 1006, 1006, 1006, 942, 942, 942, 942, 942, 1004, 1004, 1004, 940, 940
  .short 940, 940, 940, 1002, 1002, 1002, 938, 938, 938, 938, 938, 1000, 1000, 1000, 936, 936
  .short 936, 936, 936, 998, 998, 998, 934, 934, 934, 934, 934, 996, 996, 996, 932, 932
  .short 932, 932, 932, 994, 994, 994, 930, 930, 930, 930, 930, 992, 992, 992, 928, 928
  .short 928, 928, 928, 990, 990, 990, 926, 926, 926, 926, 926, 988, 988, 988, 924, 924
  .short 924, 924, 924, 986, 986, 986, 922, 922, 922, 922, 922, 984, 984, 984, 920, 920
  .short 920, 920, 920, 982, 982, 982, 918, 918, 918, 918, 918, 980, 980, 980, 916, 916
  .short 916, 916, 916, 978, 978, 978, 914, 914, 914, 914, 914, 976, 976, 976, 912, 912
  .short 912, 912, 912, 974, 974, 974, 910, 910, 910, 910, 910, 972, 972, 972, 908, 908
  .short 908, 908, 908, 970, 970, 970, 906, 906, 906, 906, 906, 968, 968, 968, 904, 904
  .short 904, 904, 904, 966, 966, 966, 902, 902, 902, 902, 902, 964, 964, 964, 900, 900
  .short 900, 900, 900, 962, 962, 962, 898, 898, 898, 898, 898, 960, 960, 960, 896, 896
  .short 896, 896, 896, 894, 894, 894, 830, 830, 830, 830, 830, 892, 892, 892, 828, 828
  .short 828, 828, 828, 890, 890, 890, 826, 826, 826, 826, 826, 888, 888, 888, 824, 824
  .short 824, 824, 824, 886, 886, 886, 822, 822, 822, 822, 822, 884, 884, 884, 820, 820
  .short 820, 820, 820, 882, 882, 882, 818, 818, 818, 818, 818, 880, 880, 880, 816, 816
  .short 816, 816, 816, 878, 878, 878, 814, 814, 814, 814, 814, 876, 876, 876, 812, 812
  .short 812, 812, 812, 874, 874, 874, 810, 810, 810, 810, 810, 872, 872, 872, 808, 808
  .short 808, 808, 808, 870, 870, 870, 806, 806, 806, 806, 806, 868, 868, 868, 804, 804
  .short 804, 804, 804, 866, 866, 866, 802, 802, 802, 802, 802, 864, 864, 864, 800, 800
  .short 800, 800, 800, 862, 862, 862, 798, 798, 798, 798, 798, 860, 860, 860, 796, 796
  .short 796, 796, 796, 858, 858, 858, 794, 794, 794, 794, 794, 856, 856, 856, 792, 792
  .short 792, 792, 792, 854, 854, 854, 790, 790, 790, 790, 790, 852, 852, 852, 788, 788
  .short 788, 788, 788, 850, 850, 850, 786, 786, 786, 786, 786, 848, 848, 848, 784, 784
  .short 784, 784, 784, 846, 846, 846, 782, 782, 782, 782, 782, 844, 844, 844, 780, 780
  .short 780, 780, 780, 842, 842, 842, 778, 778, 778, 778, 778, 840, 840, 840, 776, 776
  .short 776, 776, 776, 838, 838, 838, 774, 774, 774, 774, 774, 836, 836, 836, 772, 772
  .short 772, 772, 772, 834, 834, 834, 770, 770, 770, 770, 770, 832, 832, 832, 768, 768
  .short 768, 768, 766, 702, 702, 702, 638, 574, 574, 574, 764, 700, 700, 700, 636, 572
  .short 572, 572, 762, 698, 698, 698, 634, 570, 570, 570, 760, 696, 696, 696, 632, 568
  .short 568, 568, 758, 694, 694, 694, 630, 566, 566, 566, 756, 692, 692, 692, 628, 564
  .short 564, 564, 754, 690, 690, 690, 626, 562, 562, 562, 752, 688, 688, 688, 624, 560
  .short 560, 560, 750, 686, 686, 686, 622, 558, 558, 558, 748, 684, 684, 684, 620, 556
  .short 556, 556, 746, 682, 682, 682, 618, 554, 554, 554, 744, 680, 680, 680, 616, 552
  .short 552, 552, 742, 678, 678, 678, 614, 550, 550, 550, 740, 676, 676, 676, 612, 548
  .short 548, 548, 738, 674, 674, 674, 610, 546, 546, 546, 736, 672, 672, 672, 608, 544
  .short 544, 544, 734, 670, 670, 670, 606, 542, 542, 542, 732, 668, 668, 668, 604, 540
  .short 540, 540, 730, 666, 666, 666, 602, 538, 538, 538, 728, 664, 664, 664, 600, 536
  .short 536, 536, 726, 662, 662, 662, 598, 534, 534, 534, 724, 660, 660, 660, 596, 532
  .short 532, 532, 722, 658, 658, 658, 594, 530, 530, 530, 720, 656, 656, 656, 592, 528
  .short 528, 528, 718, 654, 654, 654, 590, 526, 526, 526, 716, 652, 652, 652, 588, 524
  .short 524, 524, 714, 650, 650, 650, 586, 522, 522, 522, 712, 648, 648, 648, 584, 520
  .short 520, 520, 710, 646, 646, 646, 582, 518, 518, 518, 708, 644, 644, 644, 580, 516
  .short 516, 516, 706, 642, 642, 642, 578, 514, 514, 514, 704, 640, 640, 640, 576, 512
  .short 512, 510, 446, 382, 318, 254, 190, 126, 62, 508, 444, 380, 316, 252, 188, 124
  .short 60, 506, 442, 378, 314, 250, 186, 122, 58, 504, 440, 376, 312, 248, 184, 120
  .short 56, 502, 438, 374, 310, 246, 182, 118, 54, 500, 436, 372, 308, 244, 180, 116
  .short 52, 498, 434, 370, 306, 242, 178, 114, 50, 496, 432, 368, 304, 240, 176, 112
  .short 48, 494, 430, 366, 302, 238, 174, 110, 46, 492, 428, 364, 300, 236, 172, 108
  .short 44, 490, 426, 362, 298, 234, 170, 106, 42, 488, 424, 360, 296, 232, 168, 104
  .short 40, 486, 422, 358, 294, 230, 166, 102, 38, 484, 420, 356, 292, 228, 164, 100
  .short 36, 482, 418, 354, 290, 226, 162, 98, 34, 480, 416, 352, 288, 224, 160, 96
  .short 32, 478, 414, 350, 286, 222, 158, 94, 30, 476, 412, 348, 284, 220, 156, 92
  .short 28, 474, 410, 346, 282, 218, 154, 90, 26, 472, 408, 344, 280, 216, 152, 88
  .short 24, 470, 406, 342, 278, 214, 150, 86, 22, 468, 404, 340, 276, 212, 148, 84
  .short 20, 466, 402, 338, 274, 210, 146, 82, 18, 464, 400, 336, 272, 208, 144, 80
  .short 16, 462, 398, 334, 270, 206, 142, 78, 14, 460, 396, 332, 268, 204, 140, 76
  .short 12, 458, 394, 330, 266, 202, 138, 74, 10, 456, 392, 328, 264, 200, 136, 72
  .short 8, 454, 390, 326, 262, 198, 134, 70, 6, 452, 388, 324, 260, 196, 132, 68
  .short 4, 450, 386, 322, 258, 194, 130, 66, 2, 448, 384, 320, 256, 192, 128, 64
  .short 0, 1536, 1536, 1536, 1536, 1536, 1536, 1536, 1536, 1536, 1536, 1536, 1536, 1536, 1536, 1536
  .short 1536, 1536, 1536, 1536, 1536, 1536, 1536, 1536, 1536, 1536, 1536, 1536, 1536, 1536, 1536, 1536
  .short 1536, 1536, 1536, 1536, 1536, 1536, 1536, 1536, 1536, 1536, 1536, 1536, 1536, 1536, 1536, 1536
  .short 1536, 1536, 1536, 1536, 1536, 1536, 1536, 1536, 1536, 1536, 1536, 1536, 1536, 1536, 1536, 1536
  .short 1536, 1536, 1536, 1536, 1536, 1536, 1536, 1536, 1536, 1536, 1536, 1536, 1536, 1536, 1536, 1536
  .short 1536, 1536, 1536, 1536, 1536, 1536, 1536, 1536, 1536, 1536, 1536, 1536, 1536, 1536, 1536, 1536
  .short 1536, 1536, 1536, 1536, 1536, 1536, 1536, 1536, 1536, 1536, 1536, 1536, 1536, 1536, 1536, 1536
  .short 1536, 1536, 1536, 1536, 1536, 1536, 1536, 1536, 1536, 1536, 1536, 1536, 1536, 1536, 1536, 1536
  .short 1536, 1536, 1536, 1536, 1536, 1536, 1536, 1536, 1536, 1536, 1536, 1536, 1536, 1536, 1536, 1536
  .short 1536, 1536, 1536, 1536, 1536, 1536, 1536, 1536, 1536, 1536, 1536, 1536, 1536, 1536, 1536, 1536
  .short 1536, 1536, 1536, 1536, 1536, 1536, 1536, 1536, 1536, 1536, 1536, 1536, 1536, 1536, 1536, 1536
  .short 1536, 1536, 1536, 1536, 1536, 1536, 1536, 1536, 1536, 1536, 1536, 1536, 1536, 1536, 1536, 1536
  .short 1536, 1536, 1536, 1536, 1536, 1536, 1536, 1536, 1536, 1536, 1536, 1536, 1536, 1536, 1536, 1536
  .short 1536, 1536, 1536, 1536, 1536, 1536, 1536, 1536, 1536, 1536, 1536, 1536, 1536, 1536, 1536, 1536
  .short 1536, 1536, 1536, 1536, 1536, 1536, 1536, 1536, 1536, 1536, 1536, 1536, 1536, 1536, 1536, 1536
  .short 1536, 1536, 1536, 1536, 1536, 1536, 1536, 1536, 1536, 1536, 1536, 1536, 1536, 1536, 1536, 1536
  .short 1536, 1536, 1536, 1536, 1536, 1536, 1536, 1536, 1536, 1536, 1536, 1536, 1536, 1536, 1536, 1536
  .short 1536, 1536, 1536, 1536, 1536, 1536, 1536, 1536, 1536, 1536, 1536, 1536, 1536, 1536, 1536, 1536
  .short 1536, 1536, 1536, 1536, 1536, 1536, 1536, 1536, 1536, 1536, 1536, 1536, 1536, 1536, 1536, 1536
  .short 1536, 1536, 1536, 1536, 1536, 1536, 1536, 1536, 1536, 1536, 1536, 1536, 1536, 1536, 1536, 1536
  .short 1536, 1536, 1536, 1536, 1536, 1536, 1536, 1536, 1536, 1536, 1536, 1536, 1536, 1536, 1536, 1536
  .short 1536, 1536, 1536, 1536, 1536, 1536, 1536, 1536, 1536, 1536, 1536, 1536, 1536, 1536, 1536, 1536
  .short 1536, 1536, 1536, 1536, 1536, 1536, 1536, 1536, 1536, 1536, 1536, 1536, 1536, 1536, 1536, 1536
  .short 1536, 1536, 1536, 1536, 1536, 1536, 1536, 1536, 1536, 1536, 1536, 1536, 1536, 1536, 1536, 1536
  .short 1536, 1536, 1536, 1536, 1536, 1536, 1536, 1536, 1536, 1536, 1536, 1536, 1536, 1536, 1536, 1536
  .short 1536, 1536, 1536, 1536, 1536, 1536, 1536, 1536, 1536, 1536, 1536, 1536, 1536, 1536, 1536, 1536
  .short 1536, 1536, 1536, 1536, 1536, 1536, 1536, 1536, 1536, 1536, 1536, 1536, 1536, 1536, 1536, 1536
  .short 1536, 1536, 1536, 1536, 1536, 1536, 1536, 1536, 1536, 1536, 1536, 1536, 1536, 1536, 1536, 1536
  .short 1536, 1536, 1536, 1536, 1536, 1536, 1536, 1536, 1536, 1536, 1536, 1536, 1536, 1536, 1536, 1536
  .short 1536, 1536, 1536, 1536, 1536, 1536, 1536, 1536, 1536, 1536, 1536, 1536, 1536, 1536, 1536, 1536
  .short 1536, 1536, 1536, 1536, 1536, 1536, 1536, 1536, 1536, 1536, 1536, 1536, 1536, 1536, 1536, 1536
  .short 1536, 1536, 1536, 1536, 1536, 1536, 1536, 1536, 1536, 1536, 1536, 1536, 1536, 1536, 1536, 1536
  .short 1536, 1536, 1536, 1536, 1536, 1536, 1536, 1536, 1536, 1536, 1536, 1536, 1536, 1536, 1536, 1536
  .short 1536, 1536, 1536, 1536, 1536, 1536, 1536, 1536, 1536, 1536, 1536, 1536, 1536, 1536, 1536, 1536
  .short 1536, 1536, 1536, 1536, 1536, 1536, 1536, 1536, 1536, 1536, 1536, 1536, 1536, 1536, 1536, 1536
  .short 1536, 1536, 1536, 1536, 1536, 1536, 1536, 1536, 1536, 1536, 1536, 1536, 1536, 1536, 1536, 1536
  .short 1536, 1536, 1536, 1536, 1536, 1536, 1536, 1536, 1536, 1536, 1536, 1536, 1536, 1536, 1536, 1536
  .short 1536, 1536, 1536, 1536, 1536, 1536, 1536, 1536, 1536, 1536, 1536, 1536, 1536, 1536, 1536, 1536
  .short 1536, 1536, 1536, 1536, 1536, 1536, 1536, 1536, 1536, 1536, 1536, 1536, 1536, 1536, 1536, 1536
  .short 1536, 1536, 1536, 1536, 1536, 1536, 1536, 1536, 1536, 1536, 1536, 1536, 1536, 1536, 1536, 1536
  .short 1536, 1536, 1536, 1536, 1536, 1536, 1536, 1536, 1536, 1536, 1536, 1536, 1536, 1536, 1536, 1536
  .short 1536, 1536, 1536, 1536, 1536, 1536, 1536, 1536, 1536, 1536, 1536, 1536, 1536, 1536, 1536, 1536
  .short 1536, 1536, 1536, 1536, 1536, 1536, 1536, 1536, 1536, 1536, 1536, 1536, 1536, 1536, 1536, 1536
  .short 1536, 1536, 1536, 1536, 1536, 1536, 1536, 1536, 1536, 1536, 1536, 1536, 1536, 1536, 1536, 1536
  .short 1536, 1536, 1536, 1536, 1536, 1536, 1536, 1536, 1536, 1536, 1536, 1536, 1536, 1536, 1536, 1536
  .short 1536, 1536, 1536, 1536, 1536, 1536, 1536, 1536, 1536, 1536, 1536, 1536, 1536, 1536, 1536, 1536
  .short 1536, 1536, 1536, 1536, 1536, 1536, 1536, 1536, 1536, 1536, 1536, 1536, 1536, 1536, 1536, 1536
  .short 1536, 1536, 1536, 1536, 1536, 1536, 1536, 1536, 1536, 1536, 1536, 1536, 1536, 1536, 1536, 1536
  .short 1536, 1536, 1536, 1536, 1536, 1536, 1536, 1536, 1536, 1536, 1536, 1536, 1536, 1536, 1536, 1536
  .short 1536, 1536, 1536, 1536, 1536, 1536, 1536, 1536, 1536, 1536, 1536, 1536, 1536, 1536, 1536, 1536
  .short 1536, 1536, 1536, 1536, 1536, 1536, 1536, 1536, 1536, 1536, 1536, 1536, 1536, 1536, 1536, 1536
  .short 1536, 1536, 1536, 1536, 1536, 1536, 1536, 1536, 1536, 1536, 1536, 1536, 1536, 1536, 1536, 1536
  .short 1536, 1536, 1536, 1536, 1536, 1536, 1536, 1536, 1536, 1536, 1536, 1536, 1536, 1536, 1536, 1536
  .short 1536, 1536, 1536, 1536, 1536, 1536, 1536, 1536, 1536, 1536, 1536, 1536, 1536, 1536, 1536, 1536
  .short 1536, 1536, 1536, 1536, 1536, 1536, 1536, 1536, 1536, 1536, 1536, 1536, 1536, 1536, 1536, 1536
  .short 1536, 1536, 1536, 1536, 1536, 1536, 1536, 1536, 1536, 1536, 1536, 1536, 1536, 1536, 1536, 1536
  .short 1536, 1536, 1536, 1536, 1536, 1536, 1536, 1536, 1536, 1536, 1536, 1536, 1536, 1536, 1536, 1536
  .short 1536, 1536, 1536, 1536, 1536, 1536, 1536, 1536, 1536, 1536, 1536, 1536, 1536, 1536, 1536, 1536
  .short 1536, 1536, 1536, 1536, 1536, 1536, 1536, 1536, 1536, 1536, 1536, 1536, 1536, 1536, 1536, 1536
  .short 1536, 1536, 1536, 1536, 1536, 1536, 1536, 1536, 1536, 1536, 1536, 1536, 1536, 1536, 1536, 1536
  .short 1536, 1536, 1536, 1536, 1536, 1536, 1536, 1536, 1536, 1536, 1536, 1536, 1536, 1536, 1536, 1536
  .short 1536, 1536, 1536, 1536, 1536, 1536, 1536, 1536, 1536, 1536, 1536, 1536, 1536, 1536, 1536, 1536
  .short 1536, 1536, 1536, 1536, 1536, 1536, 1536, 1536, 1536, 1536, 1536, 1536, 1536, 1536, 1536, 1536
  .short 1536, 1536, 1536, 1536, 1536, 1536, 1536, 1536, 1536, 1536, 1536, 1536, 1536, 1536, 1536, 1536
.size l1_idxtab, 6144
.section .rodata,"a"
.p2align 6
.amdhsa_kernel l1_kernel
  .amdhsa_next_free_vgpr 164
  .amdhsa_next_free_sgpr 102
  .amdhsa_accum_offset 164
  .amdhsa_group_segment_fixed_size 0
  .amdhsa_kernarg_size 120
  .amdhsa_user_sgpr_count 2
  .amdhsa_user_sgpr_kernarg_segment_ptr 1
  .amdhsa_system_sgpr_workgroup_id_x 1
.end_amdhsa_kernel
.text
.globl attn_kernel
.p2align 8
.type attn_kernel,@function
attn_kernel:
  s_cmp_ge_u32 s2, 256
  s_cbranch_scc1 attn_kernel_end
  s_load_dwordx2 s[4:5], s[0:1], 112
  s_and_b32 s6, s2, 7
  s_lshl_b32 s6, s6, 2
  s_lshr_b32 s7, s2, 3
  s_and_b32 s8, s7, 3
  s_add_u32 s6, s6, s8
  s_lshr_b32 s7, s2, 5
  v_and_b32 v127, 63, v0
  v_lshrrev_b32 v123, 6, v0
  v_and_b32 v124, 31, v127
  v_readfirstlane_b32 s9, v123
  v_lshlrev_b32 v123, 4, v127
  v_lshlrev_b32 v125, 2, v124
  s_cmp_ge_u32 s9, 4
  s_cbranch_scc1 attn_kernel_helper
  s_mul_i32 s13, s6, 73728
  s_lshl_b32 s14, s7, 3
  s_lshl_b32 s15, s9, 1
  s_add_u32 s14, s14, s15
  s_mul_i32 s15, s14, 1152
  s_add_u32 s13, s13, s15
  s_add_u32 s13, s13, 0
  s_mov_b32 s36, 9
  s_waitcnt lgkmcnt(0)
  s_add_u32 s20, s4, s13
  s_addc_u32 s21, s5, 0
  s_mov_b32 s22, 2304
  s_mov_b32 s23, 0x00020000
  buffer_load_dwordx4 v[72:75], v123, s[20:23], 0 offen
  buffer_load_dwordx4 v[80:83], v123, s[20:23], 0 offen offset:1152
  buffer_load_dword v76, v125, s[20:23], 0 offen offset:1024
  buffer_load_dword v84, v125, s[20:23], 0 offen offset:2176
  s_add_u32 s24, s4, 7208960
  s_addc_u32 s25, s5, 0
  s_mov_b32 s26, 2359296
  s_mov_b32 s27, 0x00020000
  v_lshrrev_b32 v126, 5, v127
  v_cmp_gt_u32 s[34:35], 32, v127
  v_mov_b32 v93, 0x3f803f80
  v_mov_b32 v94, 0
  v_mov_b32 v95, 0
  v_mov_b32 v101, 0x3f803f80
  v_mov_b32 v102, 0
  v_mov_b32 v103, 0
  v_mov_b32 v77, 0
  v_mov_b32 v78, 0
  v_mov_b32 v79, 0
  v_mov_b32 v85, 0
  v_mov_b32 v86, 0
  v_mov_b32 v87, 0
attn_kernel_rerun:
  v_and_b32 v124, 31, v127
  v_lshlrev_b32 v120, 4, v127
  v_lshlrev_b32 v121, 2, v124
  v_lshrrev_b32 v126, 5, v127
  v_mul_u32_u24 v122, 18, v126
  v_add_u32 v122, v122, v124
  v_cmp_gt_u32 vcc, 18, v124
  v_mov_b32 v116, 0
  v_mov_b32 v117, 0
  v_mov_b32 v118, 0
  v_mov_b32 v119, 0
  v_min_u32 v124, 19, v124
  v_add_u32 v124, 18, v124
  v_cndmask_b32 v122, v124, v122, vcc
  v_lshlrev_b32 v122, 4, v122
  v_mov_b32 v32, 0
  v_mov_b32 v48, 0
  v_mov_b32 v33, 0
  v_mov_b32 v49, 0
  v_mov_b32 v34, 0
  v_mov_b32 v50, 0
  v_mov_b32 v35, 0
  v_mov_b32 v51, 0
  v_mov_b32 v36, 0
  v_mov_b32 v52, 0
  v_mov_b32 v37, 0
  v_mov_b32 v53, 0
  v_mov_b32 v38, 0
  v_mov_b32 v54, 0
  v_mov_b32 v39, 0
  v_mov_b32 v55, 0
  v_mov_b32 v40, 0
  v_mov_b32 v56, 0
  v_mov_b32 v41, 0
  v_mov_b32 v57, 0
  v_mov_b32 v42, 0
  v_mov_b32 v58, 0
  v_mov_b32 v43, 0
  v_mov_b32 v59, 0
  v_mov_b32 v44, 0
  v_mov_b32 v60, 0
  v_mov_b32 v45, 0
  v_mov_b32 v61, 0
  v_mov_b32 v46, 0
  v_mov_b32 v62, 0
  v_mov_b32 v47, 0
  v_mov_b32 v63, 0
  v_mov_b32 v68, 0
  v_mov_b32 v69, 0
  v_mov_b32 v70, 0
  v_mov_b32 v71, 0
  s_cmp_eq_u32 s36, 0
  s_cbranch_scc1 attn_kernel_pipe_start
  s_waitcnt vmcnt(0)
  s_barrier
  ds_read_b128 v[88:91], v120
  ds_read_b32 v92, v121 offset:1024
  v_cndmask_b32 v76, 0, v76, s[34:35]
  v_cndmask_b32 v84, 0, v84, s[34:35]
  s_waitcnt lgkmcnt(0)
  v_mfma_f32_32x32x16_bf16 v[0:15], v[88:91], v[72:75], 0
  v_mfma_f32_32x32x16_bf16 v[16:31], v[88:91], v[80:83], 0
  v_mfma_f32_32x32x8_bf16 v[0:15], v[92:93], v[76:77], v[0:15]
  v_mfma_f32_32x32x8_bf16 v[16:31], v[92:93], v[84:85], v[16:31]
  s_nop 9
  v_max3_f32 v123, v0, v1, v2
  v_max3_f32 v123, v123, v3, v4
  v_max3_f32 v123, v123, v5, v6
  v_max3_f32 v123, v123, v7, v8
  v_max3_f32 v123, v123, v9, v10
  v_max3_f32 v123, v123, v11, v12
  v_max3_f32 v123, v123, v13, v14
  v_max_f32 v123, v123, v15
  v_cvt_pk_bf16_f32 v124, v123, v123
  v_and_b32 v124, 0xffff0000, v124
  v_sub_f32 v125, v123, v124
  v_cvt_pk_bf16_f32 v124, -v124, -v125
  v_cndmask_b32 v77, 0, v124, s[34:35]
  v_max3_f32 v123, v16, v17, v18
  v_max3_f32 v123, v123, v19, v20
  v_max3_f32 v123, v123, v21, v22
  v_max3_f32 v123, v123, v23, v24
  v_max3_f32 v123, v123, v25, v26
  v_max3_f32 v123, v123, v27, v28
  v_max3_f32 v123, v123, v29, v30
  v_max_f32 v123, v123, v31
  v_cvt_pk_bf16_f32 v124, v123, v123
  v_and_b32 v124, 0xffff0000, v124
  v_sub_f32 v125, v123, v124
  v_cvt_pk_bf16_f32 v124, -v124, -v125
  v_cndmask_b32 v85, 0, v124, s[34:35]
attn_kernel_pipe_start:
  ds_read_b128 v[88:91], v120
  ds_read_b32 v92, v121 offset:1024
  ds_read_b128 v[96:99], v120 offset:2368
  ds_read_b32 v100, v121 offset:3392
  ds_read_b128 v[104:107], v122 offset:1152
  ds_read_b128 v[108:111], v122 offset:1760
  v_mov_b32 v16, 0
  v_mov_b32 v17, 0
  v_mov_b32 v18, 0
  v_mov_b32 v19, 0
  v_mov_b32 v20, 0
  v_mov_b32 v21, 0
  v_mov_b32 v22, 0
  v_mov_b32 v23, 0
  v_mov_b32 v24, 0
  v_mov_b32 v25, 0
  v_mov_b32 v26, 0
  v_mov_b32 v27, 0
  v_mov_b32 v28, 0
  v_mov_b32 v29, 0
  v_mov_b32 v30, 0
  v_mov_b32 v31, 0
  s_waitcnt lgkmcnt(4)
  v_mfma_f32_32x32x16_bf16 v[0:15], v[88:91], v[72:75], 0
  v_mfma_f32_32x32x8_bf16 v[0:15], v[92:93], v[76:77], v[0:15]
  s_mov_b32 s31, 0
  s_nop 7
.p2align 3
attn_kernel_loop:
  s_bitcmp1_b32 s36, s31
  s_cbranch_scc1 attn_kernel_dobar0
attn_kernel_body0:
  v_cvt_pk_bf16_f32 v70, v28, v29
  v_cvt_pk_bf16_f32 v71, v30, v31
  v_exp_f32 v0, v0
  v_exp_f32 v1, v1
  v_mfma_f32_32x32x16_bf16 v[16:31], v[88:91], v[80:83], 0
  v_exp_f32 v2, v2
  v_exp_f32 v3, v3
  v_cvt_pk_bf16_f32 v64, v0, v1
  v_cvt_pk_bf16_f32 v65, v2, v3
  v_exp_f32 v4, v4
  v_exp_f32 v5, v5
  v_mfma_f32_32x32x8_bf16 v[16:31], v[92:93], v[84:85], v[16:31]
  v_exp_f32 v6, v6
  v_exp_f32 v7, v7
  v_cvt_pk_bf16_f32 v66, v4, v5
  v_cvt_pk_bf16_f32 v67, v6, v7
  v_exp_f32 v8, v8
  s_waitcnt lgkmcnt(0)
  v_exp_f32_e64 v9, v9
  v_mfma_f32_32x32x16_bf16 v[48:63], v[116:119], v[68:71], v[48:63]
  ds_read_b128 v[88:91], v120 offset:4736
  v_exp_f32 v10, v10
  v_exp_f32 v11, v11
  v_cvt_pk_bf16_f32 v68, v8, v9
  v_cvt_pk_bf16_f32 v69, v10, v11
  v_exp_f32 v12, v12
  v_exp_f32 v13, v13
  v_mfma_f32_32x32x16_bf16 v[32:47], v[104:107], v[64:67], v[32:47]
  ds_read_b32 v92, v121 offset:5760
  v_exp_f32 v14, v14
  v_exp_f32 v15, v15
  v_cvt_pk_bf16_f32 v70, v12, v13
  v_cvt_pk_bf16_f32 v71, v14, v15
  v_exp_f32 v16, v16
  v_exp_f32 v17, v17
  v_mfma_f32_32x32x16_bf16 v[0:15], v[96:99], v[72:75], 0
  ds_read_b128 v[112:115], v122 offset:3520
  v_exp_f32 v18, v18
  v_exp_f32 v19, v19
  v_cvt_pk_bf16_f32 v64, v16, v17
  v_cvt_pk_bf16_f32 v65, v18, v19
  v_exp_f32 v20, v20
  v_exp_f32 v21, v21
  v_mfma_f32_32x32x8_bf16 v[0:15], v[100:101], v[76:77], v[0:15]
  ds_read_b128 v[116:119], v122 offset:4128
  v_exp_f32 v22, v22
  v_exp_f32 v23, v23
  v_cvt_pk_bf16_f32 v66, v20, v21
  v_cvt_pk_bf16_f32 v67, v22, v23
  v_exp_f32 v24, v24
  v_exp_f32 v25, v25
  v_mfma_f32_32x32x16_bf16 v[32:47], v[108:111], v[68:71], v[32:47]
  v_exp_f32 v26, v26
  v_exp_f32 v27, v27
  v_cvt_pk_bf16_f32 v68, v24, v25
  v_cvt_pk_bf16_f32 v69, v26, v27
  v_exp_f32 v28, v28
  v_exp_f32 v29, v29
  v_mfma_f32_32x32x16_bf16 v[48:63], v[104:107], v[64:67], v[48:63]
  v_exp_f32 v30, v30
  v_exp_f32 v31, v31
  v_cvt_pk_bf16_f32 v70, v28, v29
  v_cvt_pk_bf16_f32 v71, v30, v31
  v_exp_f32 v0, v0
  v_exp_f32 v1, v1
  v_mfma_f32_32x32x16_bf16 v[16:31], v[96:99], v[80:83], 0
  v_exp_f32 v2, v2
  v_exp_f32 v3, v3
  v_cvt_pk_bf16_f32 v64, v0, v1
  v_cvt_pk_bf16_f32 v65, v2, v3
  v_exp_f32 v4, v4
  v_exp_f32 v5, v5
  v_mfma_f32_32x32x8_bf16 v[16:31], v[100:101], v[84:85], v[16:31]
  v_exp_f32 v6, v6
  v_exp_f32 v7, v7
  v_cvt_pk_bf16_f32 v66, v4, v5
  v_cvt_pk_bf16_f32 v67, v6, v7
  v_exp_f32 v8, v8
  s_waitcnt lgkmcnt(0)
  v_exp_f32_e64 v9, v9
  v_mfma_f32_32x32x16_bf16 v[48:63], v[108:111], v[68:71], v[48:63]
  ds_read_b128 v[96:99], v120 offset:7104
  v_exp_f32 v10, v10
  v_exp_f32 v11, v11
  v_cvt_pk_bf16_f32 v68, v8, v9
  v_cvt_pk_bf16_f32 v69, v10, v11
  v_exp_f32 v12, v12
  v_exp_f32 v13, v13
  v_mfma_f32_32x32x16_bf16 v[32:47], v[112:115], v[64:67], v[32:47]
  ds_read_b32 v100, v121 offset:8128
  v_exp_f32 v14, v14
  v_exp_f32 v15, v15
  v_cvt_pk_bf16_f32 v70, v12, v13
  v_cvt_pk_bf16_f32 v71, v14, v15
  v_exp_f32 v16, v16
  v_exp_f32 v17, v17
  v_mfma_f32_32x32x16_bf16 v[0:15], v[88:91], v[72:75], 0
  ds_read_b128 v[104:107], v122 offset:5888
  v_exp_f32 v18, v18
  v_exp_f32 v19, v19
  v_cvt_pk_bf16_f32 v64, v16, v17
  v_cvt_pk_bf16_f32 v65, v18, v19
  v_exp_f32 v20, v20
  v_exp_f32 v21, v21
  v_mfma_f32_32x32x8_bf16 v[0:15], v[92:93], v[76:77], v[0:15]
  ds_read_b128 v[108:111], v122 offset:6496
  v_exp_f32 v22, v22
  v_exp_f32 v23, v23
  v_cvt_pk_bf16_f32 v66, v20, v21
  v_cvt_pk_bf16_f32 v67, v22, v23
  v_exp_f32 v24, v24
  v_exp_f32 v25, v25
  v_mfma_f32_32x32x16_bf16 v[32:47], v[116:119], v[68:71], v[32:47]
  v_exp_f32 v26, v26
  v_exp_f32 v27, v27
  v_cvt_pk_bf16_f32 v68, v24, v25
  v_cvt_pk_bf16_f32 v69, v26, v27
  v_exp_f32 v28, v28
  v_exp_f32 v29, v29
  v_mfma_f32_32x32x16_bf16 v[48:63], v[112:115], v[64:67], v[48:63]
  v_exp_f32 v30, v30
  v_exp_f32 v31, v31
  v_cvt_pk_bf16_f32 v70, v28, v29
  v_cvt_pk_bf16_f32 v71, v30, v31
  v_exp_f32 v0, v0
  v_exp_f32 v1, v1
  v_mfma_f32_32x32x16_bf16 v[16:31], v[88:91], v[80:83], 0
  v_exp_f32 v2, v2
  v_exp_f32 v3, v3
  v_cvt_pk_bf16_f32 v64, v0, v1
  v_cvt_pk_bf16_f32 v65, v2, v3
  v_exp_f32 v4, v4
  v_exp_f32 v5, v5
  v_mfma_f32_32x32x8_bf16 v[16:31], v[92:93], v[84:85], v[16:31]
  v_exp_f32 v6, v6
  v_exp_f32 v7, v7
  v_cvt_pk_bf16_f32 v66, v4, v5
  v_cvt_pk_bf16_f32 v67, v6, v7
  v_exp_f32 v8, v8
  s_waitcnt lgkmcnt(0)
  v_exp_f32_e64 v9, v9
  v_mfma_f32_32x32x16_bf16 v[48:63], v[116:119], v[68:71], v[48:63]
  ds_read_b128 v[88:91], v120 offset:9472
  v_exp_f32 v10, v10
  v_exp_f32 v11, v11
  v_cvt_pk_bf16_f32 v68, v8, v9
  v_cvt_pk_bf16_f32 v69, v10, v11
  v_exp_f32 v12, v12
  v_exp_f32 v13, v13
  v_mfma_f32_32x32x16_bf16 v[32:47], v[104:107], v[64:67], v[32:47]
  ds_read_b32 v92, v121 offset:10496
  v_exp_f32 v14, v14
  v_exp_f32 v15, v15
  v_cvt_pk_bf16_f32 v70, v12, v13
  v_cvt_pk_bf16_f32 v71, v14, v15
  v_exp_f32 v16, v16
  v_exp_f32 v17, v17
  v_mfma_f32_32x32x16_bf16 v[0:15], v[96:99], v[72:75], 0
  ds_read_b128 v[112:115], v122 offset:8256
  v_exp_f32 v18, v18
  v_exp_f32 v19, v19
  v_cvt_pk_bf16_f32 v64, v16, v17
  v_cvt_pk_bf16_f32 v65, v18, v19
  v_exp_f32 v20, v20
  v_exp_f32 v21, v21
  v_mfma_f32_32x32x8_bf16 v[0:15], v[100:101], v[76:77], v[0:15]
  ds_read_b128 v[116:119], v122 offset:8864
  v_exp_f32 v22, v22
  v_exp_f32 v23, v23
  v_cvt_pk_bf16_f32 v66, v20, v21
  v_cvt_pk_bf16_f32 v67, v22, v23
  v_exp_f32 v24, v24
  v_exp_f32 v25, v25
  v_mfma_f32_32x32x16_bf16 v[32:47], v[108:111], v[68:71], v[32:47]
  v_exp_f32 v26, v26
  v_exp_f32 v27, v27
  v_cvt_pk_bf16_f32 v68, v24, v25
  v_cvt_pk_bf16_f32 v69, v26, v27
  v_exp_f32 v28, v28
  v_exp_f32 v29, v29
  v_mfma_f32_32x32x16_bf16 v[48:63], v[104:107], v[64:67], v[48:63]
  v_exp_f32 v30, v30
  v_exp_f32 v31, v31
  v_cvt_pk_bf16_f32 v70, v28, v29
  v_cvt_pk_bf16_f32 v71, v30, v31
  v_exp_f32 v0, v0
  v_exp_f32 v1, v1
  v_mfma_f32_32x32x16_bf16 v[16:31], v[96:99], v[80:83], 0
  v_exp_f32 v2, v2
  v_exp_f32 v3, v3
  v_cvt_pk_bf16_f32 v64, v0, v1
  v_cvt_pk_bf16_f32 v65, v2, v3
  v_exp_f32 v4, v4
  v_exp_f32 v5, v5
  v_mfma_f32_32x32x8_bf16 v[16:31], v[100:101], v[84:85], v[16:31]
  v_exp_f32 v6, v6
  v_exp_f32 v7, v7
  v_cvt_pk_bf16_f32 v66, v4, v5
  v_cvt_pk_bf16_f32 v67, v6, v7
  v_exp_f32 v8, v8
  s_waitcnt lgkmcnt(0)
  v_exp_f32_e64 v9, v9
  v_mfma_f32_32x32x16_bf16 v[48:63], v[108:111], v[68:71], v[48:63]
  ds_read_b128 v[96:99], v120 offset:11840
  v_exp_f32 v10, v10
  v_exp_f32 v11, v11
  v_cvt_pk_bf16_f32 v68, v8, v9
  v_cvt_pk_bf16_f32 v69, v10, v11
  v_exp_f32 v12, v12
  v_exp_f32 v13, v13
  v_mfma_f32_32x32x16_bf16 v[32:47], v[112:115], v[64:67], v[32:47]
  ds_read_b32 v100, v121 offset:12864
  v_exp_f32 v14, v14
  v_exp_f32 v15, v15
  v_cvt_pk_bf16_f32 v70, v12, v13
  v_cvt_pk_bf16_f32 v71, v14, v15
  v_exp_f32 v16, v16
  v_exp_f32 v17, v17
  v_mfma_f32_32x32x16_bf16 v[0:15], v[88:91], v[72:75], 0
  ds_read_b128 v[104:107], v122 offset:10624
  v_exp_f32 v18, v18
  v_exp_f32 v19, v19
  v_cvt_pk_bf16_f32 v64, v16, v17
  v_cvt_pk_bf16_f32 v65, v18, v19
  v_exp_f32 v20, v20
  v_exp_f32 v21, v21
  v_mfma_f32_32x32x8_bf16 v[0:15], v[92:93], v[76:77], v[0:15]
  ds_read_b128 v[108:111], v122 offset:11232
  v_exp_f32 v22, v22
  v_exp_f32 v23, v23
  v_cvt_pk_bf16_f32 v66, v20, v21
  v_cvt_pk_bf16_f32 v67, v22, v23
  v_exp_f32 v24, v24
  v_exp_f32 v25, v25
  v_mfma_f32_32x32x16_bf16 v[32:47], v[116:119], v[68:71], v[32:47]
  v_exp_f32 v26, v26
  v_exp_f32 v27, v27
  v_cvt_pk_bf16_f32 v68, v24, v25
  v_cvt_pk_bf16_f32 v69, v26, v27
  v_exp_f32 v28, v28
  v_exp_f32 v29, v29
  v_mfma_f32_32x32x16_bf16 v[48:63], v[112:115], v[64:67], v[48:63]
  v_exp_f32 v30, v30
  v_exp_f32 v31, v31
  s_add_u32 s31, s31, 1
  s_bitcmp1_b32 s36, s31
  s_cbranch_scc1 attn_kernel_dobar4
attn_kernel_body4:
  v_cvt_pk_bf16_f32 v70, v28, v29
  v_cvt_pk_bf16_f32 v71, v30, v31
  v_exp_f32 v0, v0
  v_exp_f32 v1, v1
  v_mfma_f32_32x32x16_bf16 v[16:31], v[88:91], v[80:83], 0
  v_exp_f32 v2, v2
  v_exp_f32 v3, v3
  v_cvt_pk_bf16_f32 v64, v0, v1
  v_cvt_pk_bf16_f32 v65, v2, v3
  v_exp_f32 v4, v4
  v_exp_f32 v5, v5
  v_mfma_f32_32x32x8_bf16 v[16:31], v[92:93], v[84:85], v[16:31]
  v_exp_f32 v6, v6
  v_exp_f32 v7, v7
  v_cvt_pk_bf16_f32 v66, v4, v5
  v_cvt_pk_bf16_f32 v67, v6, v7
  v_exp_f32 v8, v8
  s_waitcnt lgkmcnt(0)
  v_exp_f32_e64 v9, v9
  v_mfma_f32_32x32x16_bf16 v[48:63], v[116:119], v[68:71], v[48:63]
  ds_read_b128 v[88:91], v120 offset:14208
  v_exp_f32 v10, v10
  v_exp_f32 v11, v11
  v_cvt_pk_bf16_f32 v68, v8, v9
  v_cvt_pk_bf16_f32 v69, v10, v11
  v_exp_f32 v12, v12
  v_exp_f32 v13, v13
  v_mfma_f32_32x32x16_bf16 v[32:47], v[104:107], v[64:67], v[32:47]
  ds_read_b32 v92, v121 offset:15232
  v_exp_f32 v14, v14
  v_exp_f32 v15, v15
  v_cvt_pk_bf16_f32 v70, v12, v13
  v_cvt_pk_bf16_f32 v71, v14, v15
  v_exp_f32 v16, v16
  v_exp_f32 v17, v17
  v_mfma_f32_32x32x16_bf16 v[0:15], v[96:99], v[72:75], 0
  ds_read_b128 v[112:115], v122 offset:12992
  v_exp_f32 v18, v18
  v_exp_f32 v19, v19
  v_cvt_pk_bf16_f32 v64, v16, v17
  v_cvt_pk_bf16_f32 v65, v18, v19
  v_exp_f32 v20, v20
  v_exp_f32 v21, v21
  v_mfma_f32_32x32x8_bf16 v[0:15], v[100:101], v[76:77], v[0:15]
  ds_read_b128 v[116:119], v122 offset:13600
  v_exp_f32 v22, v22
  v_exp_f32 v23, v23
  v_cvt_pk_bf16_f32 v66, v20, v21
  v_cvt_pk_bf16_f32 v67, v22, v23
  v_exp_f32 v24, v24
  v_exp_f32 v25, v25
  v_mfma_f32_32x32x16_bf16 v[32:47], v[108:111], v[68:71], v[32:47]
  v_exp_f32 v26, v26
  v_exp_f32 v27, v27
  v_cvt_pk_bf16_f32 v68, v24, v25
  v_cvt_pk_bf16_f32 v69, v26, v27
  v_exp_f32 v28, v28
  v_exp_f32 v29, v29
  v_mfma_f32_32x32x16_bf16 v[48:63], v[104:107], v[64:67], v[48:63]
  v_exp_f32 v30, v30
  v_exp_f32 v31, v31
  v_cvt_pk_bf16_f32 v70, v28, v29
  v_cvt_pk_bf16_f32 v71, v30, v31
  v_exp_f32 v0, v0
  v_exp_f32 v1, v1
  v_mfma_f32_32x32x16_bf16 v[16:31], v[96:99], v[80:83], 0
  v_exp_f32 v2, v2
  v_exp_f32 v3, v3
  v_cvt_pk_bf16_f32 v64, v0, v1
  v_cvt_pk_bf16_f32 v65, v2, v3
  v_exp_f32 v4, v4
  v_exp_f32 v5, v5
  v_mfma_f32_32x32x8_bf16 v[16:31], v[100:101], v[84:85], v[16:31]
  v_exp_f32 v6, v6
  v_exp_f32 v7, v7
  v_cvt_pk_bf16_f32 v66, v4, v5
  v_cvt_pk_bf16_f32 v67, v6, v7
  v_exp_f32 v8, v8
  s_waitcnt lgkmcnt(0)
  v_exp_f32_e64 v9, v9
  v_mfma_f32_32x32x16_bf16 v[48:63], v[108:111], v[68:71], v[48:63]
  ds_read_b128 v[96:99], v120 offset:16576
  v_exp_f32 v10, v10
  v_exp_f32 v11, v11
  v_cvt_pk_bf16_f32 v68, v8, v9
  v_cvt_pk_bf16_f32 v69, v10, v11
  v_exp_f32 v12, v12
  v_exp_f32 v13, v13
  v_mfma_f32_32x32x16_bf16 v[32:47], v[112:115], v[64:67], v[32:47]
  ds_read_b32 v100, v121 offset:17600
  v_exp_f32 v14, v14
  v_exp_f32 v15, v15
  v_cvt_pk_bf16_f32 v70, v12, v13
  v_cvt_pk_bf16_f32 v71, v14, v15
  v_exp_f32 v16, v16
  v_exp_f32 v17, v17
  v_mfma_f32_32x32x16_bf16 v[0:15], v[88:91], v[72:75], 0
  ds_read_b128 v[104:107], v122 offset:15360
  v_exp_f32 v18, v18
  v_exp_f32 v19, v19
  v_cvt_pk_bf16_f32 v64, v16, v17
  v_cvt_pk_bf16_f32 v65, v18, v19
  v_exp_f32 v20, v20
  v_exp_f32 v21, v21
  v_mfma_f32_32x32x8_bf16 v[0:15], v[92:93], v[76:77], v[0:15]
  ds_read_b128 v[108:111], v122 offset:15968
  v_exp_f32 v22, v22
  v_exp_f32 v23, v23
  v_cvt_pk_bf16_f32 v66, v20, v21
  v_cvt_pk_bf16_f32 v67, v22, v23
  v_exp_f32 v24, v24
  v_exp_f32 v25, v25
  v_mfma_f32_32x32x16_bf16 v[32:47], v[116:119], v[68:71], v[32:47]
  v_exp_f32 v26, v26
  v_exp_f32 v27, v27
  v_cvt_pk_bf16_f32 v68, v24, v25
  v_cvt_pk_bf16_f32 v69, v26, v27
  v_exp_f32 v28, v28
  v_exp_f32 v29, v29
  v_mfma_f32_32x32x16_bf16 v[48:63], v[112:115], v[64:67], v[48:63]
  v_exp_f32 v30, v30
  v_exp_f32 v31, v31
  v_cvt_pk_bf16_f32 v70, v28, v29
  v_cvt_pk_bf16_f32 v71, v30, v31
  v_exp_f32 v0, v0
  v_exp_f32 v1, v1
  v_mfma_f32_32x32x16_bf16 v[16:31], v[88:91], v[80:83], 0
  v_exp_f32 v2, v2
  v_exp_f32 v3, v3
  v_cvt_pk_bf16_f32 v64, v0, v1
  v_cvt_pk_bf16_f32 v65, v2, v3
  v_exp_f32 v4, v4
  v_exp_f32 v5, v5
  v_mfma_f32_32x32x8_bf16 v[16:31], v[92:93], v[84:85], v[16:31]
  v_exp_f32 v6, v6
  v_exp_f32 v7, v7
  v_cvt_pk_bf16_f32 v66, v4, v5
  v_cvt_pk_bf16_f32 v67, v6, v7
  v_exp_f32 v8, v8
  s_waitcnt lgkmcnt(0)
  v_exp_f32_e64 v9, v9
  v_mfma_f32_32x32x16_bf16 v[48:63], v[116:119], v[68:71], v[48:63]
  ds_read_b128 v[88:91], v120 offset:18944
  v_exp_f32 v10, v10
  v_exp_f32 v11, v11
  v_cvt_pk_bf16_f32 v68, v8, v9
  v_cvt_pk_bf16_f32 v69, v10, v11
  v_exp_f32 v12, v12
  v_exp_f32 v13, v13
  v_mfma_f32_32x32x16_bf16 v[32:47], v[104:107], v[64:67], v[32:47]
  ds_read_b32 v92, v121 offset:19968
  v_exp_f32 v14, v14
  v_exp_f32 v15, v15
  v_cvt_pk_bf16_f32 v70, v12, v13
  v_cvt_pk_bf16_f32 v71, v14, v15
  v_exp_f32 v16, v16
  v_exp_f32 v17, v17
  v_mfma_f32_32x32x16_bf16 v[0:15], v[96:99], v[72:75], 0
  ds_read_b128 v[112:115], v122 offset:17728
  v_exp_f32 v18, v18
  v_exp_f32 v19, v19
  v_cvt_pk_bf16_f32 v64, v16, v17
  v_cvt_pk_bf16_f32 v65, v18, v19
  v_exp_f32 v20, v20
  v_exp_f32 v21, v21
  v_mfma_f32_32x32x8_bf16 v[0:15], v[100:101], v[76:77], v[0:15]
  ds_read_b128 v[116:119], v122 offset:18336
  v_exp_f32 v22, v22
  v_exp_f32 v23, v23
  v_cvt_pk_bf16_f32 v66, v20, v21
  v_cvt_pk_bf16_f32 v67, v22, v23
  v_exp_f32 v24, v24
  v_exp_f32 v25, v25
  v_mfma_f32_32x32x16_bf16 v[32:47], v[108:111], v[68:71], v[32:47]
  v_exp_f32 v26, v26
  v_exp_f32 v27, v27
  v_cvt_pk_bf16_f32 v68, v24, v25
  v_cvt_pk_bf16_f32 v69, v26, v27
  v_exp_f32 v28, v28
  v_exp_f32 v29, v29
  v_mfma_f32_32x32x16_bf16 v[48:63], v[104:107], v[64:67], v[48:63]
  v_exp_f32 v30, v30
  v_exp_f32 v31, v31
  v_cvt_pk_bf16_f32 v70, v28, v29
  v_cvt_pk_bf16_f32 v71, v30, v31
  v_exp_f32 v0, v0
  v_exp_f32 v1, v1
  v_mfma_f32_32x32x16_bf16 v[16:31], v[96:99], v[80:83], 0
  v_exp_f32 v2, v2
  v_exp_f32 v3, v3
  v_cvt_pk_bf16_f32 v64, v0, v1
  v_cvt_pk_bf16_f32 v65, v2, v3
  v_exp_f32 v4, v4
  v_exp_f32 v5, v5
  v_mfma_f32_32x32x8_bf16 v[16:31], v[100:101], v[84:85], v[16:31]
  v_exp_f32 v6, v6
  v_exp_f32 v7, v7
  v_cvt_pk_bf16_f32 v66, v4, v5
  v_cvt_pk_bf16_f32 v67, v6, v7
  v_exp_f32 v8, v8
  s_waitcnt lgkmcnt(0)
  v_exp_f32_e64 v9, v9
  v_mfma_f32_32x32x16_bf16 v[48:63], v[108:111], v[68:71], v[48:63]
  ds_read_b128 v[96:99], v120 offset:21312
  v_exp_f32 v10, v10
  v_exp_f32 v11, v11
  v_cvt_pk_bf16_f32 v68, v8, v9
  v_cvt_pk_bf16_f32 v69, v10, v11
  v_exp_f32 v12, v12
  v_exp_f32 v13, v13
  v_mfma_f32_32x32x16_bf16 v[32:47], v[112:115], v[64:67], v[32:47]
  ds_read_b32 v100, v121 offset:22336
  v_exp_f32 v14, v14
  v_exp_f32 v15, v15
  v_cvt_pk_bf16_f32 v70, v12, v13
  v_cvt_pk_bf16_f32 v71, v14, v15
  v_exp_f32 v16, v16
  v_exp_f32 v17, v17
  v_mfma_f32_32x32x16_bf16 v[0:15], v[88:91], v[72:75], 0
  ds_read_b128 v[104:107], v122 offset:20096
  v_exp_f32 v18, v18
  v_exp_f32 v19, v19
  v_cvt_pk_bf16_f32 v64, v16, v17
  v_cvt_pk_bf16_f32 v65, v18, v19
  v_exp_f32 v20, v20
  v_exp_f32 v21, v21
  v_mfma_f32_32x32x8_bf16 v[0:15], v[92:93], v[76:77], v[0:15]
  ds_read_b128 v[108:111], v122 offset:20704
  v_exp_f32 v22, v22
  v_exp_f32 v23, v23
  v_cvt_pk_bf16_f32 v66, v20, v21
  v_cvt_pk_bf16_f32 v67, v22, v23
  v_exp_f32 v24, v24
  v_exp_f32 v25, v25
  v_mfma_f32_32x32x16_bf16 v[32:47], v[116:119], v[68:71], v[32:47]
  v_exp_f32 v26, v26
  v_exp_f32 v27, v27
  v_cvt_pk_bf16_f32 v68, v24, v25
  v_cvt_pk_bf16_f32 v69, v26, v27
  v_exp_f32 v28, v28
  v_exp_f32 v29, v29
  v_mfma_f32_32x32x16_bf16 v[48:63], v[112:115], v[64:67], v[48:63]
  v_exp_f32 v30, v30
  v_exp_f32 v31, v31
  v_add_u32 v120, 18944, v120
  v_add_u32 v121, 18944, v121
  v_add_u32 v122, 18944, v122
  s_add_u32 s31, s31, 1
  s_cmp_lt_u32 s31, 16
  s_cbranch_scc1 attn_kernel_loop
  v_cvt_pk_bf16_f32 v70, v28, v29
  v_cvt_pk_bf16_f32 v71, v30, v31
  s_mov_b32 s40, 0x53800000
  v_mov_b32 v43, v42
  v_mfma_f32_32x32x16_bf16 v[48:63], v[116:119], v[68:71], v[48:63]
  s_nop 0
  v_permlane32_swap_b32 v42, v43
  s_nop 1
  v_rcp_f32 v125, v42
  v_cmp_ge_f32 vcc, s40, v42
  v_mul_f32 v0, v32, v125
  v_mul_f32 v1, v33, v125
  v_mul_f32 v2, v34, v125
  v_mul_f32 v3, v35, v125
  v_mul_f32 v4, v36, v125
  v_mul_f32 v5, v37, v125
  v_mul_f32 v6, v38, v125
  v_mul_f32 v7, v39, v125
  v_mul_f32 v8, v40, v125
  v_mul_f32 v9, v41, v125
  v_cvt_pk_bf16_f32 v0, v0, v1
  v_cvt_pk_bf16_f32 v1, v2, v3
  v_cvt_pk_bf16_f32 v2, v4, v5
  v_cvt_pk_bf16_f32 v3, v6, v7
  v_cvt_pk_bf16_f32 v4, v8, v9
  s_lshl_b32 s41, s6, 6
  s_add_u32 s41, s41, s14
  s_lshl_b32 s42, s41, 10
  s_lshl_b32 s43, s41, 7
  s_add_u32 s43, s43, 2097152
  v_lshlrev_b32 v123, 4, v127
  v_lshlrev_b32 v124, 2, v127
  v_mov_b32 v59, v58
  s_nop 1
  v_permlane32_swap_b32 v58, v59
  s_nop 1
  v_cmp_ge_f32 s[44:45], s40, v58
  v_rcp_f32 v125, v58
  s_nop 1
  s_and_b64 vcc, vcc, s[44:45]
  s_cmp_eq_u32 s36, 0
  s_cbranch_scc1 attn_kernel_fin
  s_cmp_eq_u64 vcc, -1
  s_cbranch_scc0 attn_kernel_fallback
attn_kernel_fin:
  buffer_store_dwordx4 v[0:3], v123, s[24:27], s42 offen
  v_mul_f32 v16, v48, v125
  v_mul_f32 v17, v49, v125
  v_mul_f32 v18, v50, v125
  v_mul_f32 v19, v51, v125
  v_mul_f32 v20, v52, v125
  v_mul_f32 v21, v53, v125
  v_mul_f32 v22, v54, v125
  v_mul_f32 v23, v55, v125
  v_mul_f32 v24, v56, v125
  v_mul_f32 v25, v57, v125
  v_cvt_pk_bf16_f32 v16, v16, v17
  v_cvt_pk_bf16_f32 v17, v18, v19
  v_cvt_pk_bf16_f32 v18, v20, v21
  v_cvt_pk_bf16_f32 v19, v22, v23
  v_cvt_pk_bf16_f32 v20, v24, v25
  buffer_store_dwordx4 v[16:19], v123, s[24:27], s42 offen offset:1024
  s_mov_b64 exec, s[34:35]
  buffer_store_dword v4, v124, s[24:27], s43 offen
  buffer_store_dword v20, v124, s[24:27], s43 offen offset:128
attn_kernel_end:
  s_endpgm
attn_kernel_dobar0:
  s_barrier
  s_branch attn_kernel_body0
attn_kernel_dobar4:
  s_barrier
  s_branch attn_kernel_body4
attn_kernel_fallback:
  v_mov_b32 v64, 0xff7fffff
  v_mov_b32 v65, 0xff7fffff
  v_mov_b32 v77, 0
  v_mov_b32 v85, 0
  v_and_b32 v124, 31, v127
  v_lshlrev_b32 v123, 4, v127
  v_lshlrev_b32 v125, 2, v124
  s_mov_b32 s31, 0
attn_kernel_mloop:
  ds_read_b128 v[96:99], v123
  ds_read_b32 v100, v125 offset:1024
  s_waitcnt lgkmcnt(0)
  v_mfma_f32_32x32x16_bf16 v[0:15], v[96:99], v[72:75], 0
  v_mfma_f32_32x32x16_bf16 v[16:31], v[96:99], v[80:83], 0
  v_mfma_f32_32x32x8_bf16 v[0:15], v[100:101], v[76:77], v[0:15]
  v_mfma_f32_32x32x8_bf16 v[16:31], v[100:101], v[84:85], v[16:31]
  s_nop 15
  v_max3_f32 v64, v64, v0, v1
  v_max3_f32 v64, v64, v2, v3
  v_max3_f32 v64, v64, v4, v5
  v_max3_f32 v64, v64, v6, v7
  v_max3_f32 v64, v64, v8, v9
  v_max3_f32 v64, v64, v10, v11
  v_max3_f32 v64, v64, v12, v13
  v_max3_f32 v64, v64, v14, v15
  v_max3_f32 v65, v65, v16, v17
  v_max3_f32 v65, v65, v18, v19
  v_max3_f32 v65, v65, v20, v21
  v_max3_f32 v65, v65, v22, v23
  v_max3_f32 v65, v65, v24, v25
  v_max3_f32 v65, v65, v26, v27
  v_max3_f32 v65, v65, v28, v29
  v_max3_f32 v65, v65, v30, v31
  v_add_u32 v123, 2368, v123
  v_add_u32 v125, 2368, v125
  s_add_u32 s31, s31, 1
  s_cmp_lt_u32 s31, 64
  s_cbranch_scc1 attn_kernel_mloop
  v_mov_b32 v124, v64
  s_nop 1
  v_permlane32_swap_b32 v64, v124
  s_nop 1
  v_max_f32 v0, v64, v124
  v_mov_b32 v124, v65
  s_nop 1
  v_permlane32_swap_b32 v65, v124
  s_nop 1
  v_max_f32 v16, v65, v124
  v_mov_b32 v123, v0
  v_cvt_pk_bf16_f32 v124, v123, v123
  v_and_b32 v124, 0xffff0000, v124
  v_sub_f32 v125, v123, v124
  v_cvt_pk_bf16_f32 v124, -v124, -v125
  v_cndmask_b32 v77, 0, v124, s[34:35]
  v_mov_b32 v123, v16
  v_cvt_pk_bf16_f32 v124, v123, v123
  v_and_b32 v124, 0xffff0000, v124
  v_sub_f32 v125, v123, v124
  v_cvt_pk_bf16_f32 v124, -v124, -v125
  v_cndmask_b32 v85, 0, v124, s[34:35]
  s_mov_b32 s36, 0
  s_branch attn_kernel_rerun
attn_kernel_helper:
  s_mul_i32 s12, s6, 151552
  s_add_u32 s12, s12, 2359296
  s_sub_u32 s10, s9, 4
  s_lshl_b32 s28, s10, 10
  s_waitcnt lgkmcnt(0)
  s_add_u32 s16, s4, s12
  s_addc_u32 s17, s5, 0
  s_mov_b32 s18, 151552
  s_mov_b32 s19, 0x00020000
  s_add_u32 s29, s28, 0
  s_mov_b32 m0, s29
  s_nop 0
  buffer_load_dwordx4 v123, s[16:19], s29 offen lds
  s_add_u32 s29, s28, 4096
  s_mov_b32 m0, s29
  s_nop 0
  buffer_load_dwordx4 v123, s[16:19], s29 offen lds
  s_add_u32 s29, s28, 8192
  s_mov_b32 m0, s29
  s_nop 0
  buffer_load_dwordx4 v123, s[16:19], s29 offen lds
  s_add_u32 s29, s28, 12288
  s_mov_b32 m0, s29
  s_nop 0
  buffer_load_dwordx4 v123, s[16:19], s29 offen lds
  s_add_u32 s29, s28, 16384
  s_mov_b32 m0, s29
  s_nop 0
  buffer_load_dwordx4 v123, s[16:19], s29 offen lds
  s_add_u32 s29, s28, 20480
  s_mov_b32 m0, s29
  s_nop 0
  buffer_load_dwordx4 v123, s[16:19], s29 offen lds
  s_add_u32 s29, s28, 24576
  s_mov_b32 m0, s29
  s_nop 0
  buffer_load_dwordx4 v123, s[16:19], s29 offen lds
  s_add_u32 s29, s28, 28672
  s_mov_b32 m0, s29
  s_nop 0
  buffer_load_dwordx4 v123, s[16:19], s29 offen lds
  s_add_u32 s29, s28, 32768
  s_mov_b32 m0, s29
  s_nop 0
  buffer_load_dwordx4 v123, s[16:19], s29 offen lds
  s_add_u32 s29, s28, 36864
  s_mov_b32 m0, s29
  s_nop 0
  buffer_load_dwordx4 v123, s[16:19], s29 offen lds
  s_add_u32 s29, s28, 40960
  s_mov_b32 m0, s29
  s_nop 0
  buffer_load_dwordx4 v123, s[16:19], s29 offen lds
  s_add_u32 s29, s28, 45056
  s_mov_b32 m0, s29
  s_nop 0
  buffer_load_dwordx4 v123, s[16:19], s29 offen lds
  s_waitcnt vmcnt(10)
  s_barrier
  s_add_u32 s29, s28, 49152
  s_mov_b32 m0, s29
  s_nop 0
  buffer_load_dwordx4 v123, s[16:19], s29 offen lds
  s_add_u32 s29, s28, 53248
  s_mov_b32 m0, s29
  s_nop 0
  buffer_load_dwordx4 v123, s[16:19], s29 offen lds
  s_add_u32 s29, s28, 57344
  s_mov_b32 m0, s29
  s_nop 0
  buffer_load_dwordx4 v123, s[16:19], s29 offen lds
  s_add_u32 s29, s28, 61440
  s_mov_b32 m0, s29
  s_nop 0
  buffer_load_dwordx4 v123, s[16:19], s29 offen lds
  s_add_u32 s29, s28, 65536
  s_mov_b32 m0, s29
  s_nop 0
  buffer_load_dwordx4 v123, s[16:19], s29 offen lds
  s_add_u32 s29, s28, 69632
  s_mov_b32 m0, s29
  s_nop 0
  buffer_load_dwordx4 v123, s[16:19], s29 offen lds
  s_add_u32 s29, s28, 73728
  s_mov_b32 m0, s29
  s_nop 0
  buffer_load_dwordx4 v123, s[16:19], s29 offen lds
  s_add_u32 s29, s28, 77824
  s_mov_b32 m0, s29
  s_nop 0
  buffer_load_dwordx4 v123, s[16:19], s29 offen lds
  s_waitcnt vmcnt(12)
  s_barrier
  s_add_u32 s29, s28, 81920
  s_mov_b32 m0, s29
  s_nop 0
  buffer_load_dwordx4 v123, s[16:19], s29 offen lds
  s_add_u32 s29, s28, 86016
  s_mov_b32 m0, s29
  s_nop 0
  buffer_load_dwordx4 v123, s[16:19], s29 offen lds
  s_add_u32 s29, s28, 90112
  s_mov_b32 m0, s29
  s_nop 0
  buffer_load_dwordx4 v123, s[16:19], s29 offen lds
  s_add_u32 s29, s28, 94208
  s_mov_b32 m0, s29
  s_nop 0
  buffer_load_dwordx4 v123, s[16:19], s29 offen lds
  s_add_u32 s29, s28, 98304
  s_mov_b32 m0, s29
  s_nop 0
  buffer_load_dwordx4 v123, s[16:19], s29 offen lds
  s_add_u32 s29, s28, 102400
  s_mov_b32 m0, s29
  s_nop 0
  buffer_load_dwordx4 v123, s[16:19], s29 offen lds
  s_add_u32 s29, s28, 106496
  s_mov_b32 m0, s29
  s_nop 0
  buffer_load_dwordx4 v123, s[16:19], s29 offen lds
  s_add_u32 s29, s28, 110592
  s_mov_b32 m0, s29
  s_nop 0
  buffer_load_dwordx4 v123, s[16:19], s29 offen lds
  s_add_u32 s29, s28, 114688
  s_mov_b32 m0, s29
  s_nop 0
  buffer_load_dwordx4 v123, s[16:19], s29 offen lds
  s_add_u32 s29, s28, 118784
  s_mov_b32 m0, s29
  s_nop 0
  buffer_load_dwordx4 v123, s[16:19], s29 offen lds
  s_add_u32 s29, s28, 122880
  s_mov_b32 m0, s29
  s_nop 0
  buffer_load_dwordx4 v123, s[16:19], s29 offen lds
  s_add_u32 s29, s28, 126976
  s_mov_b32 m0, s29
  s_nop 0
  buffer_load_dwordx4 v123, s[16:19], s29 offen lds
  s_add_u32 s29, s28, 131072
  s_mov_b32 m0, s29
  s_nop 0
  buffer_load_dwordx4 v123, s[16:19], s29 offen lds
  s_add_u32 s29, s28, 135168
  s_mov_b32 m0, s29
  s_nop 0
  buffer_load_dwordx4 v123, s[16:19], s29 offen lds
  s_add_u32 s29, s28, 139264
  s_mov_b32 m0, s29
  s_nop 0
  buffer_load_dwordx4 v123, s[16:19], s29 offen lds
  s_add_u32 s29, s28, 143360
  s_mov_b32 m0, s29
  s_nop 0
  buffer_load_dwordx4 v123, s[16:19], s29 offen lds
  s_add_u32 s29, s28, 147456
  s_mov_b32 m0, s29
  s_nop 0
  buffer_load_dwordx4 v123, s[16:19], s29 offen lds
  s_waitcnt vmcnt(0)
  s_barrier
  s_lshl_b32 s40, s10, 8
  s_add_u32 s40, s40, s2
  s_cmp_ge_u32 s40, 576
  s_cbranch_scc1 attn_kernel_cpf
  s_load_dwordx2 s[60:61], s[0:1], 64
  s_mul_i32 s41, s40, 4224
  s_add_u32 s41, s41, 14581760
  s_add_u32 s44, s4, s41
  s_addc_u32 s45, s5, 0
  s_mov_b32 s46, 4224
  s_mov_b32 s47, 0x00020000
  s_mul_i32 s41, s40, 4608
  s_add_u32 s41, s41, 11927552
  s_add_u32 s48, s4, s41
  s_addc_u32 s49, s5, 0
  s_mov_b32 s50, 4608
  s_mov_b32 s51, 0x00020000
  s_lshl_b32 s41, s40, 12
  s_add_u32 s41, s41, 9568256
  s_add_u32 s52, s4, s41
  s_addc_u32 s53, s5, 0
  s_mov_b32 s54, 4096
  s_mov_b32 s55, 0x00020000
  v_and_b32 v114, 15, v127
  v_lshrrev_b32 v115, 4, v127
  v_lshlrev_b32 v113, 5, v114
  v_lshl_add_u32 v113, v115, 4, v113
  v_add_u32 v113, 32, v113
  v_lshlrev_b32 v116, 3, v115
  v_sub_u32 v116, v116, v114
  v_add_u32 v116, 16, v116
  v_lshlrev_b32 v112, 1, v116
  v_mov_b32 v0, 0
  v_mov_b32 v1, 0
  v_mov_b32 v2, 0
  v_mov_b32 v3, 0
  v_mov_b32 v4, 0
  v_mov_b32 v5, 0
  v_mov_b32 v6, 0
  v_mov_b32 v7, 0
  v_mov_b32 v8, 0
  v_mov_b32 v9, 0
  v_mov_b32 v10, 0
  v_mov_b32 v11, 0
  v_mov_b32 v12, 0
  v_mov_b32 v13, 0
  v_mov_b32 v14, 0
  v_mov_b32 v15, 0
  v_mov_b32 v16, 0
  v_mov_b32 v17, 0
  v_mov_b32 v18, 0
  v_mov_b32 v19, 0
  v_mov_b32 v20, 0
  v_mov_b32 v21, 0
  v_mov_b32 v22, 0
  v_mov_b32 v23, 0
  v_mov_b32 v24, 0
  v_mov_b32 v25, 0
  v_mov_b32 v26, 0
  v_mov_b32 v27, 0
  v_mov_b32 v28, 0
  v_mov_b32 v29, 0
  v_mov_b32 v30, 0
  v_mov_b32 v31, 0
  s_mov_b32 s56, 0
  s_sub_u32 s58, 448, s56
  s_sub_u32 s59, 384, s56
  s_sub_i32 s67, 320, s56
  s_max_i32 s67, s67, 0
  s_sub_u32 s64, 4032, s56
  s_sub_u32 s65, 3968, s56
  s_sub_u32 s66, 3904, s56
  buffer_load_dwordx4 v[32:35], v113, s[48:51], s58 offen offset:0
  buffer_load_dwordx4 v[36:39], v113, s[48:51], s58 offen offset:512
  buffer_load_dwordx4 v[40:43], v113, s[48:51], s58 offen offset:1024
  buffer_load_dwordx4 v[44:47], v113, s[48:51], s58 offen offset:1536
  buffer_load_dwordx4 v[48:51], v113, s[48:51], s58 offen offset:2048
  buffer_load_dwordx4 v[52:55], v113, s[48:51], s58 offen offset:2560
  buffer_load_dwordx4 v[56:59], v113, s[48:51], s58 offen offset:3072
  buffer_load_dwordx4 v[60:63], v113, s[48:51], s58 offen offset:3584
  s_sub_u32 s62, s64, 0
  buffer_load_dwordx4 v[96:99], v112, s[44:47], s62 offen
  s_sub_u32 s62, s64, 512
  buffer_load_dwordx4 v[100:103], v112, s[44:47], s62 offen
  s_sub_u32 s62, s64, 1024
  buffer_load_dwordx4 v[104:107], v112, s[44:47], s62 offen
  s_mov_b32 s63, 0
attn_kernel_cl:
  s_waitcnt vmcnt(2)
  v_mfma_f32_16x16x32_bf16 v[0:3], v[96:99], v[32:35], v[0:3]
  s_sub_u32 s62, s64, 1536
  buffer_load_dwordx4 v[108:111], v112, s[44:47], s62 offen
  v_mfma_f32_16x16x32_bf16 v[4:7], v[96:99], v[36:39], v[4:7]
  v_mfma_f32_16x16x32_bf16 v[8:11], v[96:99], v[40:43], v[8:11]
  v_mfma_f32_16x16x32_bf16 v[12:15], v[96:99], v[44:47], v[12:15]
  v_mfma_f32_16x16x32_bf16 v[16:19], v[96:99], v[48:51], v[16:19]
  v_mfma_f32_16x16x32_bf16 v[20:23], v[96:99], v[52:55], v[20:23]
  v_mfma_f32_16x16x32_bf16 v[24:27], v[96:99], v[56:59], v[24:27]
  v_mfma_f32_16x16x32_bf16 v[28:31], v[96:99], v[60:63], v[28:31]
  s_waitcnt vmcnt(2)
  v_mfma_f32_16x16x32_bf16 v[4:7], v[100:103], v[32:35], v[4:7]
  s_sub_u32 s62, s64, 2048
  buffer_load_dwordx4 v[96:99], v112, s[44:47], s62 offen
  v_mfma_f32_16x16x32_bf16 v[8:11], v[100:103], v[36:39], v[8:11]
  v_mfma_f32_16x16x32_bf16 v[12:15], v[100:103], v[40:43], v[12:15]
  v_mfma_f32_16x16x32_bf16 v[16:19], v[100:103], v[44:47], v[16:19]
  v_mfma_f32_16x16x32_bf16 v[20:23], v[100:103], v[48:51], v[20:23]
  v_mfma_f32_16x16x32_bf16 v[24:27], v[100:103], v[52:55], v[24:27]
  v_mfma_f32_16x16x32_bf16 v[28:31], v[100:103], v[56:59], v[28:31]
  s_waitcnt vmcnt(2)
  v_mfma_f32_16x16x32_bf16 v[8:11], v[104:107], v[32:35], v[8:11]
  s_sub_u32 s62, s64, 2560
  buffer_load_dwordx4 v[100:103], v112, s[44:47], s62 offen
  v_mfma_f32_16x16x32_bf16 v[12:15], v[104:107], v[36:39], v[12:15]
  buffer_load_dwordx4 v[64:67], v113, s[48:51], s59 offen offset:0
  v_mfma_f32_16x16x32_bf16 v[16:19], v[104:107], v[40:43], v[16:19]
  buffer_load_dwordx4 v[68:71], v113, s[48:51], s59 offen offset:512
  v_mfma_f32_16x16x32_bf16 v[20:23], v[104:107], v[44:47], v[20:23]
  v_mfma_f32_16x16x32_bf16 v[24:27], v[104:107], v[48:51], v[24:27]
  v_mfma_f32_16x16x32_bf16 v[28:31], v[104:107], v[52:55], v[28:31]
  s_waitcnt vmcnt(4)
  v_mfma_f32_16x16x32_bf16 v[12:15], v[108:111], v[32:35], v[12:15]
  s_sub_u32 s62, s64, 3072
  buffer_load_dwordx4 v[104:107], v112, s[44:47], s62 offen
  v_mfma_f32_16x16x32_bf16 v[16:19], v[108:111], v[36:39], v[16:19]
  buffer_load_dwordx4 v[72:75], v113, s[48:51], s59 offen offset:1024
  v_mfma_f32_16x16x32_bf16 v[20:23], v[108:111], v[40:43], v[20:23]
  buffer_load_dwordx4 v[76:79], v113, s[48:51], s59 offen offset:1536
  v_mfma_f32_16x16x32_bf16 v[24:27], v[108:111], v[44:47], v[24:27]
  v_mfma_f32_16x16x32_bf16 v[28:31], v[108:111], v[48:51], v[28:31]
  s_waitcnt vmcnt(6)
  v_mfma_f32_16x16x32_bf16 v[16:19], v[96:99], v[32:35], v[16:19]
  s_sub_u32 s62, s64, 3584
  buffer_load_dwordx4 v[108:111], v112, s[44:47], s62 offen
  v_mfma_f32_16x16x32_bf16 v[20:23], v[96:99], v[36:39], v[20:23]
  buffer_load_dwordx4 v[80:83], v113, s[48:51], s59 offen offset:2048
  v_mfma_f32_16x16x32_bf16 v[24:27], v[96:99], v[40:43], v[24:27]
  buffer_load_dwordx4 v[84:87], v113, s[48:51], s59 offen offset:2560
  v_mfma_f32_16x16x32_bf16 v[28:31], v[96:99], v[44:47], v[28:31]
  s_waitcnt vmcnt(8)
  v_mfma_f32_16x16x32_bf16 v[20:23], v[100:103], v[32:35], v[20:23]
  s_sub_u32 s62, s65, 0
  buffer_load_dwordx4 v[96:99], v112, s[44:47], s62 offen
  v_mfma_f32_16x16x32_bf16 v[24:27], v[100:103], v[36:39], v[24:27]
  buffer_load_dwordx4 v[88:91], v113, s[48:51], s59 offen offset:3072
  v_mfma_f32_16x16x32_bf16 v[28:31], v[100:103], v[40:43], v[28:31]
  buffer_load_dwordx4 v[92:95], v113, s[48:51], s59 offen offset:3584
  s_waitcnt vmcnt(8)
  v_mfma_f32_16x16x32_bf16 v[24:27], v[104:107], v[32:35], v[24:27]
  s_sub_u32 s62, s65, 512
  buffer_load_dwordx4 v[100:103], v112, s[44:47], s62 offen
  v_mfma_f32_16x16x32_bf16 v[28:31], v[104:107], v[36:39], v[28:31]
  s_waitcnt vmcnt(6)
  v_mfma_f32_16x16x32_bf16 v[28:31], v[108:111], v[32:35], v[28:31]
  s_sub_u32 s62, s65, 1024
  buffer_load_dwordx4 v[104:107], v112, s[44:47], s62 offen
  s_waitcnt vmcnt(2)
  v_mfma_f32_16x16x32_bf16 v[0:3], v[96:99], v[64:67], v[0:3]
  s_sub_u32 s62, s65, 1536
  buffer_load_dwordx4 v[108:111], v112, s[44:47], s62 offen
  v_mfma_f32_16x16x32_bf16 v[4:7], v[96:99], v[68:71], v[4:7]
  v_mfma_f32_16x16x32_bf16 v[8:11], v[96:99], v[72:75], v[8:11]
  v_mfma_f32_16x16x32_bf16 v[12:15], v[96:99], v[76:79], v[12:15]
  v_mfma_f32_16x16x32_bf16 v[16:19], v[96:99], v[80:83], v[16:19]
  v_mfma_f32_16x16x32_bf16 v[20:23], v[96:99], v[84:87], v[20:23]
  v_mfma_f32_16x16x32_bf16 v[24:27], v[96:99], v[88:91], v[24:27]
  v_mfma_f32_16x16x32_bf16 v[28:31], v[96:99], v[92:95], v[28:31]
  s_waitcnt vmcnt(2)
  v_mfma_f32_16x16x32_bf16 v[4:7], v[100:103], v[64:67], v[4:7]
  s_sub_u32 s62, s65, 2048
  buffer_load_dwordx4 v[96:99], v112, s[44:47], s62 offen
  v_mfma_f32_16x16x32_bf16 v[8:11], v[100:103], v[68:71], v[8:11]
  v_mfma_f32_16x16x32_bf16 v[12:15], v[100:103], v[72:75], v[12:15]
  v_mfma_f32_16x16x32_bf16 v[16:19], v[100:103], v[76:79], v[16:19]
  v_mfma_f32_16x16x32_bf16 v[20:23], v[100:103], v[80:83], v[20:23]
  v_mfma_f32_16x16x32_bf16 v[24:27], v[100:103], v[84:87], v[24:27]
  v_mfma_f32_16x16x32_bf16 v[28:31], v[100:103], v[88:91], v[28:31]
  s_waitcnt vmcnt(2)
  v_mfma_f32_16x16x32_bf16 v[8:11], v[104:107], v[64:67], v[8:11]
  s_sub_u32 s62, s65, 2560
  buffer_load_dwordx4 v[100:103], v112, s[44:47], s62 offen
  v_mfma_f32_16x16x32_bf16 v[12:15], v[104:107], v[68:71], v[12:15]
  buffer_load_dwordx4 v[32:35], v113, s[48:51], s67 offen offset:0
  v_mfma_f32_16x16x32_bf16 v[16:19], v[104:107], v[72:75], v[16:19]
  buffer_load_dwordx4 v[36:39], v113, s[48:51], s67 offen offset:512
  v_mfma_f32_16x16x32_bf16 v[20:23], v[104:107], v[76:79], v[20:23]
  v_mfma_f32_16x16x32_bf16 v[24:27], v[104:107], v[80:83], v[24:27]
  v_mfma_f32_16x16x32_bf16 v[28:31], v[104:107], v[84:87], v[28:31]
  s_waitcnt vmcnt(4)
  v_mfma_f32_16x16x32_bf16 v[12:15], v[108:111], v[64:67], v[12:15]
  s_sub_u32 s62, s65, 3072
  buffer_load_dwordx4 v[104:107], v112, s[44:47], s62 offen
  v_mfma_f32_16x16x32_bf16 v[16:19], v[108:111], v[68:71], v[16:19]
  buffer_load_dwordx4 v[40:43], v113, s[48:51], s67 offen offset:1024
  v_mfma_f32_16x16x32_bf16 v[20:23], v[108:111], v[72:75], v[20:23]
  buffer_load_dwordx4 v[44:47], v113, s[48:51], s67 offen offset:1536
  v_mfma_f32_16x16x32_bf16 v[24:27], v[108:111], v[76:79], v[24:27]
  v_mfma_f32_16x16x32_bf16 v[28:31], v[108:111], v[80:83], v[28:31]
  s_waitcnt vmcnt(6)
  v_mfma_f32_16x16x32_bf16 v[16:19], v[96:99], v[64:67], v[16:19]
  s_sub_u32 s62, s65, 3584
  buffer_load_dwordx4 v[108:111], v112, s[44:47], s62 offen
  v_mfma_f32_16x16x32_bf16 v[20:23], v[96:99], v[68:71], v[20:23]
  buffer_load_dwordx4 v[48:51], v113, s[48:51], s67 offen offset:2048
  v_mfma_f32_16x16x32_bf16 v[24:27], v[96:99], v[72:75], v[24:27]
  buffer_load_dwordx4 v[52:55], v113, s[48:51], s67 offen offset:2560
  v_mfma_f32_16x16x32_bf16 v[28:31], v[96:99], v[76:79], v[28:31]
  s_waitcnt vmcnt(8)
  v_mfma_f32_16x16x32_bf16 v[20:23], v[100:103], v[64:67], v[20:23]
  s_sub_u32 s62, s66, 0
  buffer_load_dwordx4 v[96:99], v112, s[44:47], s62 offen
  v_mfma_f32_16x16x32_bf16 v[24:27], v[100:103], v[68:71], v[24:27]
  buffer_load_dwordx4 v[56:59], v113, s[48:51], s67 offen offset:3072
  v_mfma_f32_16x16x32_bf16 v[28:31], v[100:103], v[72:75], v[28:31]
  buffer_load_dwordx4 v[60:63], v113, s[48:51], s67 offen offset:3584
  s_waitcnt vmcnt(8)
  v_mfma_f32_16x16x32_bf16 v[24:27], v[104:107], v[64:67], v[24:27]
  s_sub_u32 s62, s66, 512
  buffer_load_dwordx4 v[100:103], v112, s[44:47], s62 offen
  v_mfma_f32_16x16x32_bf16 v[28:31], v[104:107], v[68:71], v[28:31]
  s_waitcnt vmcnt(6)
  v_mfma_f32_16x16x32_bf16 v[28:31], v[108:111], v[64:67], v[28:31]
  s_sub_u32 s62, s66, 1024
  buffer_load_dwordx4 v[104:107], v112, s[44:47], s62 offen
  s_add_u32 s56, s56, 128
  s_sub_u32 s58, 448, s56
  s_sub_u32 s59, 384, s56
  s_sub_i32 s67, 320, s56
  s_max_i32 s67, s67, 0
  s_sub_u32 s64, 4032, s56
  s_sub_u32 s65, 3968, s56
  s_sub_u32 s66, 3904, s56
  s_add_u32 s63, s63, 1
  s_cmp_lt_u32 s63, 4
  s_cbranch_scc1 attn_kernel_cl
  s_waitcnt vmcnt(0) lgkmcnt(0)
  s_add_u32 s44, s60, 0
  s_addc_u32 s45, s61, 0
  s_mov_b32 s46, 1152
  s_mov_b32 s47, 0x00020000
  s_lshl_b32 s41, s40, 1
  v_mov_b32 v116, s41
  buffer_load_ushort v116, v116, s[44:47], 0 offen
  v_lshlrev_b32 v113, 5, v114
  v_lshl_add_u32 v113, v115, 3, v113
  s_movk_i32 s41, 512
  buffer_load_dwordx2 v[32:33], v113, s[48:51], s41 offen offset:0
  buffer_load_dwordx2 v[34:35], v113, s[48:51], s41 offen offset:512
  buffer_load_dwordx2 v[36:37], v113, s[48:51], s41 offen offset:1024
  buffer_load_dwordx2 v[38:39], v113, s[48:51], s41 offen offset:1536
  buffer_load_dwordx2 v[40:41], v113, s[48:51], s41 offen offset:2048
  buffer_load_dwordx2 v[42:43], v113, s[48:51], s41 offen offset:2560
  buffer_load_dwordx2 v[44:45], v113, s[48:51], s41 offen offset:3072
  buffer_load_dwordx2 v[46:47], v113, s[48:51], s41 offen offset:3584
  s_waitcnt vmcnt(0)
  v_lshlrev_b32 v68, 16, v116
  v_lshlrev_b32 v69, 16, v116
  v_cvt_pk_bf16_f32 v0, v0, v1
  v_cvt_pk_bf16_f32 v1, v2, v3
  v_lshlrev_b32 v64, 16, v32
  v_and_b32 v65, 0xffff0000, v32
  v_pk_mul_f32 v[64:65], v[64:65], v[68:69]
  v_cvt_pk_bf16_f32 v64, v64, v65
  v_lshlrev_b32 v66, 16, v0
  v_and_b32 v67, 0xffff0000, v0
  v_and_b32 v65, 0xffff0000, v64
  v_lshlrev_b32 v64, 16, v64
  v_pk_add_f32 v[64:65], v[64:65], v[66:67]
  v_cvt_pk_bf16_f32 v0, v64, v65
  v_lshlrev_b32 v64, 16, v33
  v_and_b32 v65, 0xffff0000, v33
  v_pk_mul_f32 v[64:65], v[64:65], v[68:69]
  v_cvt_pk_bf16_f32 v64, v64, v65
  v_lshlrev_b32 v66, 16, v1
  v_and_b32 v67, 0xffff0000, v1
  v_and_b32 v65, 0xffff0000, v64
  v_lshlrev_b32 v64, 16, v64
  v_pk_add_f32 v[64:65], v[64:65], v[66:67]
  v_cvt_pk_bf16_f32 v1, v64, v65
  buffer_store_dwordx2 v[0:1], v113, s[52:55], 0 offen offset:0
  v_cvt_pk_bf16_f32 v4, v4, v5
  v_cvt_pk_bf16_f32 v5, v6, v7
  v_lshlrev_b32 v64, 16, v34
  v_and_b32 v65, 0xffff0000, v34
  v_pk_mul_f32 v[64:65], v[64:65], v[68:69]
  v_cvt_pk_bf16_f32 v64, v64, v65
  v_lshlrev_b32 v66, 16, v4
  v_and_b32 v67, 0xffff0000, v4
  v_and_b32 v65, 0xffff0000, v64
  v_lshlrev_b32 v64, 16, v64
  v_pk_add_f32 v[64:65], v[64:65], v[66:67]
  v_cvt_pk_bf16_f32 v4, v64, v65
  v_lshlrev_b32 v64, 16, v35
  v_and_b32 v65, 0xffff0000, v35
  v_pk_mul_f32 v[64:65], v[64:65], v[68:69]
  v_cvt_pk_bf16_f32 v64, v64, v65
  v_lshlrev_b32 v66, 16, v5
  v_and_b32 v67, 0xffff0000, v5
  v_and_b32 v65, 0xffff0000, v64
  v_lshlrev_b32 v64, 16, v64
  v_pk_add_f32 v[64:65], v[64:65], v[66:67]
  v_cvt_pk_bf16_f32 v5, v64, v65
  buffer_store_dwordx2 v[4:5], v113, s[52:55], 0 offen offset:512
  v_cvt_pk_bf16_f32 v8, v8, v9
  v_cvt_pk_bf16_f32 v9, v10, v11
  v_lshlrev_b32 v64, 16, v36
  v_and_b32 v65, 0xffff0000, v36
  v_pk_mul_f32 v[64:65], v[64:65], v[68:69]
  v_cvt_pk_bf16_f32 v64, v64, v65
  v_lshlrev_b32 v66, 16, v8
  v_and_b32 v67, 0xffff0000, v8
  v_and_b32 v65, 0xffff0000, v64
  v_lshlrev_b32 v64, 16, v64
  v_pk_add_f32 v[64:65], v[64:65], v[66:67]
  v_cvt_pk_bf16_f32 v8, v64, v65
  v_lshlrev_b32 v64, 16, v37
  v_and_b32 v65, 0xffff0000, v37
  v_pk_mul_f32 v[64:65], v[64:65], v[68:69]
  v_cvt_pk_bf16_f32 v64, v64, v65
  v_lshlrev_b32 v66, 16, v9
  v_and_b32 v67, 0xffff0000, v9
  v_and_b32 v65, 0xffff0000, v64
  v_lshlrev_b32 v64, 16, v64
  v_pk_add_f32 v[64:65], v[64:65], v[66:67]
  v_cvt_pk_bf16_f32 v9, v64, v65
  buffer_store_dwordx2 v[8:9], v113, s[52:55], 0 offen offset:1024
  v_cvt_pk_bf16_f32 v12, v12, v13
  v_cvt_pk_bf16_f32 v13, v14, v15
  v_lshlrev_b32 v64, 16, v38
  v_and_b32 v65, 0xffff0000, v38
  v_pk_mul_f32 v[64:65], v[64:65], v[68:69]
  v_cvt_pk_bf16_f32 v64, v64, v65
  v_lshlrev_b32 v66, 16, v12
  v_and_b32 v67, 0xffff0000, v12
  v_and_b32 v65, 0xffff0000, v64
  v_lshlrev_b32 v64, 16, v64
  v_pk_add_f32 v[64:65], v[64:65], v[66:67]
  v_cvt_pk_bf16_f32 v12, v64, v65
  v_lshlrev_b32 v64, 16, v39
  v_and_b32 v65, 0xffff0000, v39
  v_pk_mul_f32 v[64:65], v[64:65], v[68:69]
  v_cvt_pk_bf16_f32 v64, v64, v65
  v_lshlrev_b32 v66, 16, v13
  v_and_b32 v67, 0xffff0000, v13
  v_and_b32 v65, 0xffff0000, v64
  v_lshlrev_b32 v64, 16, v64
  v_pk_add_f32 v[64:65], v[64:65], v[66:67]
  v_cvt_pk_bf16_f32 v13, v64, v65
  buffer_store_dwordx2 v[12:13], v113, s[52:55], 0 offen offset:1536
  v_cvt_pk_bf16_f32 v16, v16, v17
  v_cvt_pk_bf16_f32 v17, v18, v19
  v_lshlrev_b32 v64, 16, v40
  v_and_b32 v65, 0xffff0000, v40
  v_pk_mul_f32 v[64:65], v[64:65], v[68:69]
  v_cvt_pk_bf16_f32 v64, v64, v65
  v_lshlrev_b32 v66, 16, v16
  v_and_b32 v67, 0xffff0000, v16
  v_and_b32 v65, 0xffff0000, v64
  v_lshlrev_b32 v64, 16, v64
  v_pk_add_f32 v[64:65], v[64:65], v[66:67]
  v_cvt_pk_bf16_f32 v16, v64, v65
  v_lshlrev_b32 v64, 16, v41
  v_and_b32 v65, 0xffff0000, v41
  v_pk_mul_f32 v[64:65], v[64:65], v[68:69]
  v_cvt_pk_bf16_f32 v64, v64, v65
  v_lshlrev_b32 v66, 16, v17
  v_and_b32 v67, 0xffff0000, v17
  v_and_b32 v65, 0xffff0000, v64
  v_lshlrev_b32 v64, 16, v64
  v_pk_add_f32 v[64:65], v[64:65], v[66:67]
  v_cvt_pk_bf16_f32 v17, v64, v65
  buffer_store_dwordx2 v[16:17], v113, s[52:55], 0 offen offset:2048
  v_cvt_pk_bf16_f32 v20, v20, v21
  v_cvt_pk_bf16_f32 v21, v22, v23
  v_lshlrev_b32 v64, 16, v42
  v_and_b32 v65, 0xffff0000, v42
  v_pk_mul_f32 v[64:65], v[64:65], v[68:69]
  v_cvt_pk_bf16_f32 v64, v64, v65
  v_lshlrev_b32 v66, 16, v20
  v_and_b32 v67, 0xffff0000, v20
  v_and_b32 v65, 0xffff0000, v64
  v_lshlrev_b32 v64, 16, v64
  v_pk_add_f32 v[64:65], v[64:65], v[66:67]
  v_cvt_pk_bf16_f32 v20, v64, v65
  v_lshlrev_b32 v64, 16, v43
  v_and_b32 v65, 0xffff0000, v43
  v_pk_mul_f32 v[64:65], v[64:65], v[68:69]
  v_cvt_pk_bf16_f32 v64, v64, v65
  v_lshlrev_b32 v66, 16, v21
  v_and_b32 v67, 0xffff0000, v21
  v_and_b32 v65, 0xffff0000, v64
  v_lshlrev_b32 v64, 16, v64
  v_pk_add_f32 v[64:65], v[64:65], v[66:67]
  v_cvt_pk_bf16_f32 v21, v64, v65
  buffer_store_dwordx2 v[20:21], v113, s[52:55], 0 offen offset:2560
  v_cvt_pk_bf16_f32 v24, v24, v25
  v_cvt_pk_bf16_f32 v25, v26, v27
  v_lshlrev_b32 v64, 16, v44
  v_and_b32 v65, 0xffff0000, v44
  v_pk_mul_f32 v[64:65], v[64:65], v[68:69]
  v_cvt_pk_bf16_f32 v64, v64, v65
  v_lshlrev_b32 v66, 16, v24
  v_and_b32 v67, 0xffff0000, v24
  v_and_b32 v65, 0xffff0000, v64
  v_lshlrev_b32 v64, 16, v64
  v_pk_add_f32 v[64:65], v[64:65], v[66:67]
  v_cvt_pk_bf16_f32 v24, v64, v65
  v_lshlrev_b32 v64, 16, v45
  v_and_b32 v65, 0xffff0000, v45
  v_pk_mul_f32 v[64:65], v[64:65], v[68:69]
  v_cvt_pk_bf16_f32 v64, v64, v65
  v_lshlrev_b32 v66, 16, v25
  v_and_b32 v67, 0xffff0000, v25
  v_and_b32 v65, 0xffff0000, v64
  v_lshlrev_b32 v64, 16, v64
  v_pk_add_f32 v[64:65], v[64:65], v[66:67]
  v_cvt_pk_bf16_f32 v25, v64, v65
  buffer_store_dwordx2 v[24:25], v113, s[52:55], 0 offen offset:3072
  v_cvt_pk_bf16_f32 v28, v28, v29
  v_cvt_pk_bf16_f32 v29, v30, v31
  v_lshlrev_b32 v64, 16, v46
  v_and_b32 v65, 0xffff0000, v46
  v_pk_mul_f32 v[64:65], v[64:65], v[68:69]
  v_cvt_pk_bf16_f32 v64, v64, v65
  v_lshlrev_b32 v66, 16, v28
  v_and_b32 v67, 0xffff0000, v28
  v_and_b32 v65, 0xffff0000, v64
  v_lshlrev_b32 v64, 16, v64
  v_pk_add_f32 v[64:65], v[64:65], v[66:67]
  v_cvt_pk_bf16_f32 v28, v64, v65
  v_lshlrev_b32 v64, 16, v47
  v_and_b32 v65, 0xffff0000, v47
  v_pk_mul_f32 v[64:65], v[64:65], v[68:69]
  v_cvt_pk_bf16_f32 v64, v64, v65
  v_lshlrev_b32 v66, 16, v29
  v_and_b32 v67, 0xffff0000, v29
  v_and_b32 v65, 0xffff0000, v64
  v_lshlrev_b32 v64, 16, v64
  v_pk_add_f32 v[64:65], v[64:65], v[66:67]
  v_cvt_pk_bf16_f32 v29, v64, v65
  buffer_store_dwordx2 v[28:29], v113, s[52:55], 0 offen offset:3584
  s_branch attn_kernel_cend
attn_kernel_cpf:
  s_cmp_lg_u32 s10, 3
  s_cbranch_scc1 attn_kernel_cend
  s_load_dwordx2 s[60:61], s[0:1], 88
  s_lshr_b32 s41, s2, 3
  s_mul_i32 s41, s41, 162
  v_add_u32 v0, s41, v127
  v_lshlrev_b32 v0, 7, v0
  s_waitcnt lgkmcnt(0)
  s_add_u32 s44, s60, 0
  s_addc_u32 s45, s61, 0
  s_mov_b32 s46, 663552
  s_mov_b32 s47, 0x00020000
  buffer_load_dword v1, v0, s[44:47], 0 offen offset:0
  s_mov_b32 s41, 8192
  buffer_load_dword v2, v0, s[44:47], s41 offen
  s_mov_b32 s41, 16384
  buffer_load_dword v3, v0, s[44:47], s41 offen
  s_mov_b32 s41, 24576
  s_waitcnt vmcnt(0)
attn_kernel_cend:
  s_endpgm
.section .rodata,"a"
.p2align 6
.amdhsa_kernel attn_kernel
  .amdhsa_next_free_vgpr 128
  .amdhsa_next_free_sgpr 102
  .amdhsa_accum_offset 128
  .amdhsa_group_segment_fixed_size 0
  .amdhsa_kernarg_size 120
  .amdhsa_user_sgpr_count 2
  .amdhsa_user_sgpr_kernarg_segment_ptr 1
  .amdhsa_system_sgpr_workgroup_id_x 1
.end_amdhsa_kernel
.text
.globl l3_kernel
.p2align 8
.type l3_kernel,@function
l3_kernel:
  s_cmp_ge_u32 s2, 256
  s_cbranch_scc1 l3_kernel_end
  s_cmp_ge_u32 s2, 192
  s_cbranch_scc1 l3f
  s_load_dwordx4 s[4:7], s[0:1], 88
  s_load_dwordx2 s[8:9], s[0:1], 112
  s_and_b32 s10, s2, 7
  s_lshr_b32 s11, s2, 3
  s_lshl_b32 s24, s10, 2
  s_and_b32 s25, s11, 3
  s_add_u32 s24, s24, s25
  s_lshr_b32 s25, s11, 2
  v_and_b32 v146, 63, v0
  v_lshrrev_b32 v147, 6, v0
  s_mul_i32 s29, s25, 192
  v_readfirstlane_b32 s28, v147
  v_add_u32 v147, 0, v146
  v_mul_u32_u24 v148, 5462, v147
  v_lshrrev_b32 v148, 16, v148
  v_mul_u32_u24 v149, 12, v148
  v_sub_u32 v149, v147, v149
  v_mul_u32_u24 v148, 1152, v148
  v_lshl_add_u32 v152, v149, 4, v148
  v_add_u32 v147, 64, v146
  v_mul_u32_u24 v148, 5462, v147
  v_lshrrev_b32 v148, 16, v148
  v_mul_u32_u24 v149, 12, v148
  v_sub_u32 v149, v147, v149
  v_mul_u32_u24 v148, 1152, v148
  v_lshl_add_u32 v153, v149, 4, v148
  v_add_u32 v147, 128, v146
  v_mul_u32_u24 v148, 5462, v147
  v_lshrrev_b32 v148, 16, v148
  v_mul_u32_u24 v149, 12, v148
  v_sub_u32 v149, v147, v149
  v_mul_u32_u24 v148, 1152, v148
  v_lshl_add_u32 v154, v149, 4, v148
  s_and_b32 s30, s28, 1
  s_lshr_b32 s31, s28, 1
  s_lshl_b32 s32, s24, 1
  s_add_u32 s32, s32, s30
  v_lshlrev_b32 v155, 4, v146
  s_lshl_b32 s33, s31, 4
  s_lshl_b32 s34, s33, 6
  s_add_u32 s34, s34, s32
  s_lshl_b32 s34, s34, 10
  v_lshrrev_b32 v148, 5, v146
  v_lshlrev_b32 v156, 15, v148
  v_and_b32 v149, 31, v146
  v_lshl_add_u32 v156, v149, 2, v156
  s_lshl_b32 s35, s33, 13
  s_lshl_b32 s36, s32, 7
  s_add_u32 s35, s35, s36
  s_add_u32 s35, s35, 2097152
  s_lshr_b32 s36, s28, 1
  s_and_b32 s37, s28, 1
  s_mul_i32 s37, s37, 18
  s_add_u32 s36, s36, s37
  s_mul_i32 s38, s36, 18432
  s_mul_i32 s39, s36, 3072
  s_waitcnt lgkmcnt(0)
  s_add_u32 s12, s4, s29
  s_addc_u32 s13, s5, 0
  s_sub_u32 s14, 663552, s29
  s_mov_b32 s15, 0x00020000
  s_add_u32 s16, s8, 7208960
  s_addc_u32 s17, s9, 0
  s_mov_b32 s18, 2359296
  s_mov_b32 s19, 0x00020000
  s_add_u32 s20, s6, 0
  s_addc_u32 s21, s7, 0
  s_mov_b32 s22, 4718592
  s_mov_b32 s23, 0x00020000
  s_add_u32 s40, s38, 0
  s_add_u32 m0, s39, 0
  s_nop 0
  buffer_load_dwordx4 v152, s[12:15], s40 offen lds
  s_add_u32 s40, s38, 0
  s_add_u32 m0, s39, 1024
  s_nop 0
  buffer_load_dwordx4 v153, s[12:15], s40 offen lds
  s_add_u32 s40, s38, 0
  s_add_u32 m0, s39, 2048
  s_nop 0
  buffer_load_dwordx4 v154, s[12:15], s40 offen lds
  s_add_u32 s40, s38, 36864
  s_add_u32 m0, s39, 6144
  s_nop 0
  buffer_load_dwordx4 v152, s[12:15], s40 offen lds
  s_add_u32 s40, s38, 36864
  s_add_u32 m0, s39, 7168
  s_nop 0
  buffer_load_dwordx4 v153, s[12:15], s40 offen lds
  s_add_u32 s40, s38, 36864
  s_add_u32 m0, s39, 8192
  s_nop 0
  buffer_load_dwordx4 v154, s[12:15], s40 offen lds
  s_add_u32 s40, s38, 73728
  s_add_u32 m0, s39, 12288
  s_nop 0
  buffer_load_dwordx4 v152, s[12:15], s40 offen lds
  s_add_u32 s40, s38, 73728
  s_add_u32 m0, s39, 13312
  s_nop 0
  buffer_load_dwordx4 v153, s[12:15], s40 offen lds
  s_add_u32 s40, s38, 73728
  s_add_u32 m0, s39, 14336
  s_nop 0
  buffer_load_dwordx4 v154, s[12:15], s40 offen lds
  s_add_u32 s41, s34, 0
  buffer_load_dwordx4 v[48:51], v155, s[16:19], s41 offen
  s_add_u32 s41, s34, 65536
  buffer_load_dwordx4 v[52:55], v155, s[16:19], s41 offen
  s_add_u32 s41, s34, 131072
  buffer_load_dwordx4 v[56:59], v155, s[16:19], s41 offen
  s_add_u32 s41, s34, 196608
  buffer_load_dwordx4 v[60:63], v155, s[16:19], s41 offen
  s_add_u32 s41, s34, 262144
  buffer_load_dwordx4 v[64:67], v155, s[16:19], s41 offen
  s_add_u32 s40, s38, 110592
  s_add_u32 m0, s39, 18432
  s_nop 0
  buffer_load_dwordx4 v152, s[12:15], s40 offen lds
  s_add_u32 s40, s38, 110592
  s_add_u32 m0, s39, 19456
  s_nop 0
  buffer_load_dwordx4 v153, s[12:15], s40 offen lds
  s_add_u32 s40, s38, 110592
  s_add_u32 m0, s39, 20480
  s_nop 0
  buffer_load_dwordx4 v154, s[12:15], s40 offen lds
  s_add_u32 s40, s38, 147456
  s_add_u32 m0, s39, 24576
  s_nop 0
  buffer_load_dwordx4 v152, s[12:15], s40 offen lds
  s_add_u32 s40, s38, 147456
  s_add_u32 m0, s39, 25600
  s_nop 0
  buffer_load_dwordx4 v153, s[12:15], s40 offen lds
  s_add_u32 s40, s38, 147456
  s_add_u32 m0, s39, 26624
  s_nop 0
  buffer_load_dwordx4 v154, s[12:15], s40 offen lds
  s_add_u32 s40, s38, 184320
  s_add_u32 m0, s39, 30720
  s_nop 0
  buffer_load_dwordx4 v152, s[12:15], s40 offen lds
  s_add_u32 s40, s38, 184320
  s_add_u32 m0, s39, 31744
  s_nop 0
  buffer_load_dwordx4 v153, s[12:15], s40 offen lds
  s_add_u32 s40, s38, 184320
  s_add_u32 m0, s39, 32768
  s_nop 0
  buffer_load_dwordx4 v154, s[12:15], s40 offen lds
  s_add_u32 s41, s34, 327680
  buffer_load_dwordx4 v[68:71], v155, s[16:19], s41 offen
  s_add_u32 s41, s34, 393216
  buffer_load_dwordx4 v[72:75], v155, s[16:19], s41 offen
  s_add_u32 s41, s34, 458752
  buffer_load_dwordx4 v[76:79], v155, s[16:19], s41 offen
  s_add_u32 s41, s34, 524288
  buffer_load_dwordx4 v[80:83], v155, s[16:19], s41 offen
  s_add_u32 s41, s34, 589824
  buffer_load_dwordx4 v[84:87], v155, s[16:19], s41 offen
  v_lshrrev_b32 v148, 5, v146
  v_lshrrev_b32 v149, 2, v146
  v_and_b32 v149, 3, v149
  v_lshrrev_b32 v150, 4, v146
  v_and_b32 v150, 1, v150
  v_and_b32 v151, 3, v146
  v_lshl_add_u32 v150, v150, 2, v151
  v_lshlrev_b32 v150, 2, v150
  v_mov_b32 v151, 0x75643120
  v_lshrrev_b32 v151, v150, v151
  v_and_b32 v151, 15, v151
  v_lshlrev_b32 v151, 3, v151
  v_lshl_add_u32 v147, v148, 2, v149
  v_mul_u32_u24 v144, 192, v147
  v_add_u32 v144, v144, v151
  s_mul_i32 s36, s31, 55296
  v_add_u32 v144, s36, v144
  v_lshrrev_b32 v147, 1, v149
  v_lshl_add_u32 v147, v148, 2, v147
  v_mul_u32_u24 v147, 18, v147
  v_and_b32 v149, 1, v149
  v_add3_u32 v147, v147, v149, 16
  v_mul_u32_u24 v145, 192, v147
  v_add_u32 v145, v145, v151
  v_add_u32 v145, s36, v145
  v_mov_b32 v0, 0
  v_mov_b32 v1, 0
  v_mov_b32 v2, 0
  v_mov_b32 v3, 0
  v_mov_b32 v4, 0
  v_mov_b32 v5, 0
  v_mov_b32 v6, 0
  v_mov_b32 v7, 0
  v_mov_b32 v8, 0
  v_mov_b32 v9, 0
  v_mov_b32 v10, 0
  v_mov_b32 v11, 0
  v_mov_b32 v12, 0
  v_mov_b32 v13, 0
  v_mov_b32 v14, 0
  v_mov_b32 v15, 0
  v_mov_b32 v16, 0
  v_mov_b32 v17, 0
  v_mov_b32 v18, 0
  v_mov_b32 v19, 0
  v_mov_b32 v20, 0
  v_mov_b32 v21, 0
  v_mov_b32 v22, 0
  v_mov_b32 v23, 0
  v_mov_b32 v24, 0
  v_mov_b32 v25, 0
  v_mov_b32 v26, 0
  v_mov_b32 v27, 0
  v_mov_b32 v28, 0
  v_mov_b32 v29, 0
  v_mov_b32 v30, 0
  v_mov_b32 v31, 0
  v_mov_b32 v32, 0
  v_mov_b32 v33, 0
  v_mov_b32 v34, 0
  v_mov_b32 v35, 0
  v_mov_b32 v36, 0
  v_mov_b32 v37, 0
  v_mov_b32 v38, 0
  v_mov_b32 v39, 0
  v_mov_b32 v40, 0
  v_mov_b32 v41, 0
  v_mov_b32 v42, 0
  v_mov_b32 v43, 0
  v_mov_b32 v44, 0
  v_mov_b32 v45, 0
  v_mov_b32 v46, 0
  v_mov_b32 v47, 0
  s_waitcnt vmcnt(14)
  s_barrier
  ds_read_b64_tr_b16 v[120:121], v144 offset:0
  ds_read_b64_tr_b16 v[122:123], v144 offset:1536
  ds_read_b64_tr_b16 v[124:125], v144 offset:64
  ds_read_b64_tr_b16 v[126:127], v144 offset:1600
  ds_read_b64_tr_b16 v[128:129], v144 offset:128
  ds_read_b64_tr_b16 v[130:131], v144 offset:1664
  s_waitcnt lgkmcnt(0)
  v_mfma_f32_32x32x16_bf16 v[0:15], v[120:123], v[48:51], v[0:15]
  ds_read_b64_tr_b16 v[132:133], v144 offset:3456
  ds_read_b64_tr_b16 v[134:135], v144 offset:4992
  s_add_u32 s40, s38, 221184
  s_add_u32 m0, s39, 36864
  s_nop 0
  buffer_load_dwordx4 v152, s[12:15], s40 offen lds
  s_add_u32 s40, s38, 221184
  s_add_u32 m0, s39, 37888
  s_nop 0
  buffer_load_dwordx4 v153, s[12:15], s40 offen lds
  v_mfma_f32_32x32x16_bf16 v[16:31], v[124:127], v[48:51], v[16:31]
  ds_read_b64_tr_b16 v[136:137], v144 offset:3520
  ds_read_b64_tr_b16 v[138:139], v144 offset:5056
  s_add_u32 s40, s38, 221184
  s_add_u32 m0, s39, 38912
  s_nop 0
  buffer_load_dwordx4 v154, s[12:15], s40 offen lds
  s_add_u32 s40, s38, 258048
  s_add_u32 m0, s39, 43008
  s_nop 0
  buffer_load_dwordx4 v152, s[12:15], s40 offen lds
  v_mfma_f32_32x32x16_bf16 v[32:47], v[128:131], v[48:51], v[32:47]
  ds_read_b64_tr_b16 v[140:141], v144 offset:3584
  ds_read_b64_tr_b16 v[142:143], v144 offset:5120
  s_add_u32 s40, s38, 258048
  s_add_u32 m0, s39, 44032
  s_nop 0
  buffer_load_dwordx4 v153, s[12:15], s40 offen lds
  s_add_u32 s40, s38, 258048
  s_add_u32 m0, s39, 45056
  s_nop 0
  buffer_load_dwordx4 v154, s[12:15], s40 offen lds
  s_waitcnt lgkmcnt(0)
  v_mfma_f32_32x32x16_bf16 v[0:15], v[132:135], v[52:55], v[0:15]
  ds_read_b64_tr_b16 v[120:121], v144 offset:6912
  ds_read_b64_tr_b16 v[122:123], v144 offset:8448
  s_add_u32 s40, s38, 294912
  s_add_u32 m0, s39, 49152
  s_nop 0
  buffer_load_dwordx4 v152, s[12:15], s40 offen lds
  s_add_u32 s40, s38, 294912
  s_add_u32 m0, s39, 50176
  s_nop 0
  buffer_load_dwordx4 v153, s[12:15], s40 offen lds
  v_mfma_f32_32x32x16_bf16 v[16:31], v[136:139], v[52:55], v[16:31]
  ds_read_b64_tr_b16 v[124:125], v144 offset:6976
  ds_read_b64_tr_b16 v[126:127], v144 offset:8512
  s_add_u32 s40, s38, 294912
  s_add_u32 m0, s39, 51200
  s_nop 0
  buffer_load_dwordx4 v154, s[12:15], s40 offen lds
  s_add_u32 s41, s34, 655360
  buffer_load_dwordx4 v[88:91], v155, s[16:19], s41 offen
  v_mfma_f32_32x32x16_bf16 v[32:47], v[140:143], v[52:55], v[32:47]
  ds_read_b64_tr_b16 v[128:129], v144 offset:7040
  ds_read_b64_tr_b16 v[130:131], v144 offset:8576
  s_add_u32 s41, s34, 720896
  buffer_load_dwordx4 v[92:95], v155, s[16:19], s41 offen
  s_add_u32 s41, s34, 786432
  buffer_load_dwordx4 v[96:99], v155, s[16:19], s41 offen
  s_waitcnt lgkmcnt(0)
  v_mfma_f32_32x32x16_bf16 v[0:15], v[120:123], v[56:59], v[0:15]
  ds_read_b64_tr_b16 v[132:133], v144 offset:10368
  ds_read_b64_tr_b16 v[134:135], v144 offset:11904
  s_add_u32 s41, s34, 851968
  buffer_load_dwordx4 v[100:103], v155, s[16:19], s41 offen
  s_add_u32 s41, s34, 917504
  buffer_load_dwordx4 v[104:107], v155, s[16:19], s41 offen
  v_mfma_f32_32x32x16_bf16 v[16:31], v[124:127], v[56:59], v[16:31]
  ds_read_b64_tr_b16 v[136:137], v144 offset:10432
  ds_read_b64_tr_b16 v[138:139], v144 offset:11968
  s_add_u32 s41, s34, 983040
  buffer_load_dwordx4 v[108:111], v155, s[16:19], s41 offen
  s_add_u32 s41, s35, 0
  buffer_load_dword v112, v156, s[16:19], s41 offen
  v_mfma_f32_32x32x16_bf16 v[32:47], v[128:131], v[56:59], v[32:47]
  ds_read_b64_tr_b16 v[140:141], v144 offset:10496
  ds_read_b64_tr_b16 v[142:143], v144 offset:12032
  s_add_u32 s41, s35, 8192
  buffer_load_dword v113, v156, s[16:19], s41 offen
  s_add_u32 s41, s35, 16384
  buffer_load_dword v114, v156, s[16:19], s41 offen
  s_waitcnt lgkmcnt(0)
  v_mfma_f32_32x32x16_bf16 v[0:15], v[132:135], v[60:63], v[0:15]
  ds_read_b64_tr_b16 v[120:121], v144 offset:13824
  ds_read_b64_tr_b16 v[122:123], v144 offset:15360
  s_add_u32 s41, s35, 24576
  buffer_load_dword v115, v156, s[16:19], s41 offen
  s_add_u32 s41, s35, 65536
  buffer_load_dword v116, v156, s[16:19], s41 offen
  v_mfma_f32_32x32x16_bf16 v[16:31], v[136:139], v[60:63], v[16:31]
  ds_read_b64_tr_b16 v[124:125], v144 offset:13888
  ds_read_b64_tr_b16 v[126:127], v144 offset:15424
  s_add_u32 s41, s35, 73728
  buffer_load_dword v117, v156, s[16:19], s41 offen
  s_add_u32 s41, s35, 81920
  buffer_load_dword v118, v156, s[16:19], s41 offen
  v_mfma_f32_32x32x16_bf16 v[32:47], v[140:143], v[60:63], v[32:47]
  ds_read_b64_tr_b16 v[128:129], v144 offset:13952
  ds_read_b64_tr_b16 v[130:131], v144 offset:15488
  s_add_u32 s41, s35, 90112
  buffer_load_dword v119, v156, s[16:19], s41 offen
  s_waitcnt lgkmcnt(0)
  v_mfma_f32_32x32x16_bf16 v[0:15], v[120:123], v[64:67], v[0:15]
  v_mfma_f32_32x32x16_bf16 v[16:31], v[124:127], v[64:67], v[16:31]
  v_mfma_f32_32x32x16_bf16 v[32:47], v[128:131], v[64:67], v[32:47]
  s_waitcnt vmcnt(23)
  s_barrier
  ds_read_b64_tr_b16 v[132:133], v144 offset:17280
  ds_read_b64_tr_b16 v[134:135], v144 offset:18816
  ds_read_b64_tr_b16 v[136:137], v144 offset:17344
  ds_read_b64_tr_b16 v[138:139], v144 offset:18880
  ds_read_b64_tr_b16 v[140:141], v144 offset:17408
  ds_read_b64_tr_b16 v[142:143], v144 offset:18944
  s_waitcnt lgkmcnt(0)
  v_mfma_f32_32x32x16_bf16 v[0:15], v[132:135], v[68:71], v[0:15]
  ds_read_b64_tr_b16 v[120:121], v144 offset:20736
  ds_read_b64_tr_b16 v[122:123], v144 offset:22272
  v_mfma_f32_32x32x16_bf16 v[16:31], v[136:139], v[68:71], v[16:31]
  ds_read_b64_tr_b16 v[124:125], v144 offset:20800
  ds_read_b64_tr_b16 v[126:127], v144 offset:22336
  v_mfma_f32_32x32x16_bf16 v[32:47], v[140:143], v[68:71], v[32:47]
  ds_read_b64_tr_b16 v[128:129], v144 offset:20864
  ds_read_b64_tr_b16 v[130:131], v144 offset:22400
  s_waitcnt lgkmcnt(0)
  v_mfma_f32_32x32x16_bf16 v[0:15], v[120:123], v[72:75], v[0:15]
  ds_read_b64_tr_b16 v[132:133], v144 offset:24192
  ds_read_b64_tr_b16 v[134:135], v144 offset:25728
  v_mfma_f32_32x32x16_bf16 v[16:31], v[124:127], v[72:75], v[16:31]
  ds_read_b64_tr_b16 v[136:137], v144 offset:24256
  ds_read_b64_tr_b16 v[138:139], v144 offset:25792
  v_mfma_f32_32x32x16_bf16 v[32:47], v[128:131], v[72:75], v[32:47]
  ds_read_b64_tr_b16 v[140:141], v144 offset:24320
  ds_read_b64_tr_b16 v[142:143], v144 offset:25856
  s_waitcnt lgkmcnt(0)
  v_mfma_f32_32x32x16_bf16 v[0:15], v[132:135], v[76:79], v[0:15]
  ds_read_b64_tr_b16 v[120:121], v144 offset:27648
  ds_read_b64_tr_b16 v[122:123], v144 offset:29184
  v_mfma_f32_32x32x16_bf16 v[16:31], v[136:139], v[76:79], v[16:31]
  ds_read_b64_tr_b16 v[124:125], v144 offset:27712
  ds_read_b64_tr_b16 v[126:127], v144 offset:29248
  v_mfma_f32_32x32x16_bf16 v[32:47], v[140:143], v[76:79], v[32:47]
  ds_read_b64_tr_b16 v[128:129], v144 offset:27776
  ds_read_b64_tr_b16 v[130:131], v144 offset:29312
  s_waitcnt lgkmcnt(0)
  v_mfma_f32_32x32x16_bf16 v[0:15], v[120:123], v[80:83], v[0:15]
  ds_read_b64_tr_b16 v[132:133], v144 offset:31104
  ds_read_b64_tr_b16 v[134:135], v144 offset:32640
  v_mfma_f32_32x32x16_bf16 v[16:31], v[124:127], v[80:83], v[16:31]
  ds_read_b64_tr_b16 v[136:137], v144 offset:31168
  ds_read_b64_tr_b16 v[138:139], v144 offset:32704
  v_mfma_f32_32x32x16_bf16 v[32:47], v[128:131], v[80:83], v[32:47]
  ds_read_b64_tr_b16 v[140:141], v144 offset:31232
  ds_read_b64_tr_b16 v[142:143], v144 offset:32768
  s_waitcnt lgkmcnt(0)
  v_mfma_f32_32x32x16_bf16 v[0:15], v[132:135], v[84:87], v[0:15]
  v_mfma_f32_32x32x16_bf16 v[16:31], v[136:139], v[84:87], v[16:31]
  v_mfma_f32_32x32x16_bf16 v[32:47], v[140:143], v[84:87], v[32:47]
  s_waitcnt vmcnt(0)
  s_barrier
  ds_read_b64_tr_b16 v[120:121], v144 offset:34560
  ds_read_b64_tr_b16 v[122:123], v144 offset:36096
  ds_read_b64_tr_b16 v[124:125], v144 offset:34624
  ds_read_b64_tr_b16 v[126:127], v144 offset:36160
  ds_read_b64_tr_b16 v[128:129], v144 offset:34688
  ds_read_b64_tr_b16 v[130:131], v144 offset:36224
  s_waitcnt lgkmcnt(0)
  v_mfma_f32_32x32x16_bf16 v[0:15], v[120:123], v[88:91], v[0:15]
  ds_read_b64_tr_b16 v[132:133], v144 offset:38016
  ds_read_b64_tr_b16 v[134:135], v144 offset:39552
  v_mfma_f32_32x32x16_bf16 v[16:31], v[124:127], v[88:91], v[16:31]
  ds_read_b64_tr_b16 v[136:137], v144 offset:38080
  ds_read_b64_tr_b16 v[138:139], v144 offset:39616
  v_mfma_f32_32x32x16_bf16 v[32:47], v[128:131], v[88:91], v[32:47]
  ds_read_b64_tr_b16 v[140:141], v144 offset:38144
  ds_read_b64_tr_b16 v[142:143], v144 offset:39680
  s_waitcnt lgkmcnt(0)
  v_mfma_f32_32x32x16_bf16 v[0:15], v[132:135], v[92:95], v[0:15]
  ds_read_b64_tr_b16 v[120:121], v144 offset:41472
  ds_read_b64_tr_b16 v[122:123], v144 offset:43008
  v_mfma_f32_32x32x16_bf16 v[16:31], v[136:139], v[92:95], v[16:31]
  ds_read_b64_tr_b16 v[124:125], v144 offset:41536
  ds_read_b64_tr_b16 v[126:127], v144 offset:43072
  v_mfma_f32_32x32x16_bf16 v[32:47], v[140:143], v[92:95], v[32:47]
  ds_read_b64_tr_b16 v[128:129], v144 offset:41600
  ds_read_b64_tr_b16 v[130:131], v144 offset:43136
  s_waitcnt lgkmcnt(0)
  v_mfma_f32_32x32x16_bf16 v[0:15], v[120:123], v[96:99], v[0:15]
  ds_read_b64_tr_b16 v[132:133], v144 offset:44928
  ds_read_b64_tr_b16 v[134:135], v144 offset:46464
  v_mfma_f32_32x32x16_bf16 v[16:31], v[124:127], v[96:99], v[16:31]
  ds_read_b64_tr_b16 v[136:137], v144 offset:44992
  ds_read_b64_tr_b16 v[138:139], v144 offset:46528
  v_mfma_f32_32x32x16_bf16 v[32:47], v[128:131], v[96:99], v[32:47]
  ds_read_b64_tr_b16 v[140:141], v144 offset:45056
  ds_read_b64_tr_b16 v[142:143], v144 offset:46592
  s_waitcnt lgkmcnt(0)
  v_mfma_f32_32x32x16_bf16 v[0:15], v[132:135], v[100:103], v[0:15]
  ds_read_b64_tr_b16 v[120:121], v144 offset:48384
  ds_read_b64_tr_b16 v[122:123], v144 offset:49920
  v_mfma_f32_32x32x16_bf16 v[16:31], v[136:139], v[100:103], v[16:31]
  ds_read_b64_tr_b16 v[124:125], v144 offset:48448
  ds_read_b64_tr_b16 v[126:127], v144 offset:49984
  v_mfma_f32_32x32x16_bf16 v[32:47], v[140:143], v[100:103], v[32:47]
  ds_read_b64_tr_b16 v[128:129], v144 offset:48512
  ds_read_b64_tr_b16 v[130:131], v144 offset:50048
  s_waitcnt lgkmcnt(0)
  v_mfma_f32_32x32x16_bf16 v[0:15], v[120:123], v[104:107], v[0:15]
  ds_read_b64_tr_b16 v[132:133], v144 offset:51840
  ds_read_b64_tr_b16 v[134:135], v144 offset:53376
  v_mfma_f32_32x32x16_bf16 v[16:31], v[124:127], v[104:107], v[16:31]
  ds_read_b64_tr_b16 v[136:137], v144 offset:51904
  ds_read_b64_tr_b16 v[138:139], v144 offset:53440
  v_mfma_f32_32x32x16_bf16 v[32:47], v[128:131], v[104:107], v[32:47]
  ds_read_b64_tr_b16 v[140:141], v144 offset:51968
  ds_read_b64_tr_b16 v[142:143], v144 offset:53504
  s_waitcnt lgkmcnt(0)
  v_mfma_f32_32x32x16_bf16 v[0:15], v[132:135], v[108:111], v[0:15]
  ds_read_b64_tr_b16 v[120:121], v145 offset:0
  ds_read_b64_tr_b16 v[122:123], v145 offset:6912
  v_mfma_f32_32x32x16_bf16 v[16:31], v[136:139], v[108:111], v[16:31]
  ds_read_b64_tr_b16 v[124:125], v145 offset:64
  ds_read_b64_tr_b16 v[126:127], v145 offset:6976
  v_mfma_f32_32x32x16_bf16 v[32:47], v[140:143], v[108:111], v[32:47]
  ds_read_b64_tr_b16 v[128:129], v145 offset:128
  ds_read_b64_tr_b16 v[130:131], v145 offset:7040
  s_waitcnt lgkmcnt(0)
  v_mfma_f32_32x32x16_bf16 v[0:15], v[120:123], v[112:115], v[0:15]
  ds_read_b64_tr_b16 v[132:133], v145 offset:27648
  ds_read_b64_tr_b16 v[134:135], v145 offset:34560
  v_mfma_f32_32x32x16_bf16 v[16:31], v[124:127], v[112:115], v[16:31]
  ds_read_b64_tr_b16 v[136:137], v145 offset:27712
  ds_read_b64_tr_b16 v[138:139], v145 offset:34624
  v_mfma_f32_32x32x16_bf16 v[32:47], v[128:131], v[112:115], v[32:47]
  ds_read_b64_tr_b16 v[140:141], v145 offset:27776
  ds_read_b64_tr_b16 v[142:143], v145 offset:34688
  s_waitcnt lgkmcnt(0)
  v_mfma_f32_32x32x16_bf16 v[0:15], v[132:135], v[116:119], v[0:15]
  v_mfma_f32_32x32x16_bf16 v[16:31], v[136:139], v[116:119], v[16:31]
  v_mfma_f32_32x32x16_bf16 v[32:47], v[140:143], v[116:119], v[32:47]
  s_barrier
  v_lshlrev_b32 v147, 4, v146
  s_mul_i32 s36, s30, 12288
  v_add_u32 v147, s36, v147
  v_and_b32 v148, 31, v146
  s_lshl_b32 s36, s32, 5
  v_add_u32 v148, s36, v148
  s_movk_i32 s37, 2304
  v_mul_lo_u32 v148, v148, s37
  v_lshrrev_b32 v149, 5, v146
  v_lshl_add_u32 v148, v149, 4, v148
  s_add_u32 s36, s29, 1152
  s_cmp_eq_u32 s31, 0
  s_cbranch_scc1 l3o_k0
  ds_write_b128 v147, v[0:3] offset:0
  ds_write_b128 v147, v[4:7] offset:1024
  ds_write_b128 v147, v[8:11] offset:2048
  ds_write_b128 v147, v[12:15] offset:3072
  ds_write_b128 v147, v[16:19] offset:4096
  ds_write_b128 v147, v[20:23] offset:5120
  ds_write_b128 v147, v[24:27] offset:6144
  ds_write_b128 v147, v[28:31] offset:7168
  s_waitcnt lgkmcnt(0)
  s_barrier
  ds_read_b128 v[48:51], v147 offset:8192
  ds_read_b128 v[52:55], v147 offset:9216
  ds_read_b128 v[56:59], v147 offset:10240
  ds_read_b128 v[60:63], v147 offset:11264
  s_waitcnt lgkmcnt(0)
  v_add_f32 v32, v32, v48
  v_add_f32 v33, v33, v49
  v_add_f32 v34, v34, v50
  v_add_f32 v35, v35, v51
  v_add_f32 v36, v36, v52
  v_add_f32 v37, v37, v53
  v_add_f32 v38, v38, v54
  v_add_f32 v39, v39, v55
  v_add_f32 v40, v40, v56
  v_add_f32 v41, v41, v57
  v_add_f32 v42, v42, v58
  v_add_f32 v43, v43, v59
  v_add_f32 v44, v44, v60
  v_add_f32 v45, v45, v61
  v_add_f32 v46, v46, v62
  v_add_f32 v47, v47, v63
  v_cvt_pk_bf16_f32 v32, v32, v33
  v_cvt_pk_bf16_f32 v33, v34, v35
  v_cvt_pk_bf16_f32 v34, v36, v37
  v_cvt_pk_bf16_f32 v35, v38, v39
  v_cvt_pk_bf16_f32 v36, v40, v41
  v_cvt_pk_bf16_f32 v37, v42, v43
  v_cvt_pk_bf16_f32 v38, v44, v45
  v_cvt_pk_bf16_f32 v39, v46, v47
  buffer_store_dwordx4 v[32:35], v148, s[20:23], s36 offen offset:128
  buffer_store_dwordx4 v[36:39], v148, s[20:23], s36 offen offset:160
  s_endpgm
l3o_k0:
  ds_write_b128 v147, v[32:35] offset:8192
  ds_write_b128 v147, v[36:39] offset:9216
  ds_write_b128 v147, v[40:43] offset:10240
  ds_write_b128 v147, v[44:47] offset:11264
  s_waitcnt lgkmcnt(0)
  s_barrier
  ds_read_b128 v[48:51], v147 offset:0
  ds_read_b128 v[52:55], v147 offset:1024
  ds_read_b128 v[56:59], v147 offset:2048
  ds_read_b128 v[60:63], v147 offset:3072
  ds_read_b128 v[64:67], v147 offset:4096
  ds_read_b128 v[68:71], v147 offset:5120
  ds_read_b128 v[72:75], v147 offset:6144
  ds_read_b128 v[76:79], v147 offset:7168
  s_waitcnt lgkmcnt(0)
  v_add_f32 v0, v0, v48
  v_add_f32 v1, v1, v49
  v_add_f32 v2, v2, v50
  v_add_f32 v3, v3, v51
  v_add_f32 v4, v4, v52
  v_add_f32 v5, v5, v53
  v_add_f32 v6, v6, v54
  v_add_f32 v7, v7, v55
  v_add_f32 v8, v8, v56
  v_add_f32 v9, v9, v57
  v_add_f32 v10, v10, v58
  v_add_f32 v11, v11, v59
  v_add_f32 v12, v12, v60
  v_add_f32 v13, v13, v61
  v_add_f32 v14, v14, v62
  v_add_f32 v15, v15, v63
  v_cvt_pk_bf16_f32 v0, v0, v1
  v_cvt_pk_bf16_f32 v1, v2, v3
  v_cvt_pk_bf16_f32 v2, v4, v5
  v_cvt_pk_bf16_f32 v3, v6, v7
  v_cvt_pk_bf16_f32 v4, v8, v9
  v_cvt_pk_bf16_f32 v5, v10, v11
  v_cvt_pk_bf16_f32 v6, v12, v13
  v_cvt_pk_bf16_f32 v7, v14, v15
  buffer_store_dwordx4 v[0:3], v148, s[20:23], s36 offen offset:0
  buffer_store_dwordx4 v[4:7], v148, s[20:23], s36 offen offset:32
  v_add_f32 v16, v16, v64
  v_add_f32 v17, v17, v65
  v_add_f32 v18, v18, v66
  v_add_f32 v19, v19, v67
  v_add_f32 v20, v20, v68
  v_add_f32 v21, v21, v69
  v_add_f32 v22, v22, v70
  v_add_f32 v23, v23, v71
  v_add_f32 v24, v24, v72
  v_add_f32 v25, v25, v73
  v_add_f32 v26, v26, v74
  v_add_f32 v27, v27, v75
  v_add_f32 v28, v28, v76
  v_add_f32 v29, v29, v77
  v_add_f32 v30, v30, v78
  v_add_f32 v31, v31, v79
  v_cvt_pk_bf16_f32 v16, v16, v17
  v_cvt_pk_bf16_f32 v17, v18, v19
  v_cvt_pk_bf16_f32 v18, v20, v21
  v_cvt_pk_bf16_f32 v19, v22, v23
  v_cvt_pk_bf16_f32 v20, v24, v25
  v_cvt_pk_bf16_f32 v21, v26, v27
  v_cvt_pk_bf16_f32 v22, v28, v29
  v_cvt_pk_bf16_f32 v23, v30, v31
  buffer_store_dwordx4 v[16:19], v148, s[20:23], s36 offen offset:64
  buffer_store_dwordx4 v[20:23], v148, s[20:23], s36 offen offset:96
  s_endpgm
l3f:
  s_load_dwordx2 s[8:9], s[0:1], 96
  s_load_dwordx2 s[10:11], s[0:1], 112
  v_lshrrev_b32 v1, 6, v0
  v_and_b32 v0, 63, v0
  v_readfirstlane_b32 s28, v1
  s_sub_u32 s29, s2, 192
  s_lshl_b32 s40, s29, 5
  v_lshrrev_b32 v1, 2, v0
  s_mul_i32 s41, s28, 144
  s_mul_i32 s30, s28, 9216
  v_lshlrev_b32 v6, 12, v1
  v_and_b32 v2, 3, v0
  v_lshl_add_u32 v6, v2, 4, v6
  s_lshl_b32 s35, s41, 12
  s_lshl_b32 s36, s40, 1
  s_add_u32 s35, s35, s36
  s_waitcnt lgkmcnt(0)
  s_add_u32 s24, s10, 9568256
  s_addc_u32 s25, s11, 0
  s_mov_b32 s26, 2359296
  s_mov_b32 s27, 0x00020000
  s_add_u32 s37, s35, 0
  s_add_u32 m0, s30, 0
  s_nop 0
  buffer_load_dwordx4 v6, s[24:27], s37 offen lds
  s_add_u32 s37, s35, 65536
  s_add_u32 m0, s30, 1024
  s_nop 0
  buffer_load_dwordx4 v6, s[24:27], s37 offen lds
  s_add_u32 s37, s35, 131072
  s_add_u32 m0, s30, 2048
  s_nop 0
  buffer_load_dwordx4 v6, s[24:27], s37 offen lds
  s_add_u32 s37, s35, 196608
  s_add_u32 m0, s30, 3072
  s_nop 0
  buffer_load_dwordx4 v6, s[24:27], s37 offen lds
  s_add_u32 s37, s35, 262144
  s_add_u32 m0, s30, 4096
  s_nop 0
  buffer_load_dwordx4 v6, s[24:27], s37 offen lds
  s_add_u32 s37, s35, 327680
  s_add_u32 m0, s30, 5120
  s_nop 0
  buffer_load_dwordx4 v6, s[24:27], s37 offen lds
  s_add_u32 s37, s35, 393216
  s_add_u32 m0, s30, 6144
  s_nop 0
  buffer_load_dwordx4 v6, s[24:27], s37 offen lds
  s_add_u32 s37, s35, 458752
  s_add_u32 m0, s30, 7168
  s_nop 0
  buffer_load_dwordx4 v6, s[24:27], s37 offen lds
  s_add_u32 s37, s35, 524288
  s_add_u32 m0, s30, 8192
  s_nop 0
  buffer_load_dwordx4 v6, s[24:27], s37 offen lds
  s_add_u32 s20, s8, 0
  s_addc_u32 s21, s9, 0
  s_mov_b32 s22, 4718592
  s_mov_b32 s23, 0x00020000
  v_and_b32 v1, 15, v0
  v_lshrrev_b32 v2, 4, v0
  v_mul_u32_u24 v8, 2304, v1
  v_lshl_add_u32 v8, v2, 4, v8
  v_cmp_gt_u32 vcc, 2, v2
  v_mov_b32 v4, 0x7ffffff0
  v_lshrrev_b32 v3, 2, v0
  v_cndmask_b32 v10, v4, v8, vcc
  v_and_b32 v3, 3, v3
  v_lshl_add_u32 v3, v2, 3, v3
  v_lshlrev_b32 v3, 6, v3
  v_and_b32 v4, 3, v0
  v_lshl_add_u32 v3, v4, 3, v3
  v_add_u32 v3, s30, v3
  s_mul_i32 s35, s40, 2304
  s_lshl_b32 s36, s41, 1
  s_add_u32 s35, s35, s36
  s_waitcnt vmcnt(7)
  ds_read_b64_tr_b16 v[16:17], v3 offset:0
  ds_read_b64_tr_b16 v[18:19], v3 offset:256
  s_waitcnt lgkmcnt(0)
  s_add_u32 s37, s35, 0
  buffer_store_dwordx4 v[16:19], v8, s[20:23], s37 offen
  ds_read_b64_tr_b16 v[20:21], v3 offset:32
  ds_read_b64_tr_b16 v[22:23], v3 offset:288
  s_waitcnt lgkmcnt(0)
  s_add_u32 s37, s35, 36864
  buffer_store_dwordx4 v[20:23], v8, s[20:23], s37 offen
  s_waitcnt vmcnt(7)
  ds_read_b64_tr_b16 v[24:25], v3 offset:2048
  ds_read_b64_tr_b16 v[26:27], v3 offset:2304
  s_waitcnt lgkmcnt(0)
  s_add_u32 s37, s35, 64
  buffer_store_dwordx4 v[24:27], v8, s[20:23], s37 offen
  ds_read_b64_tr_b16 v[28:29], v3 offset:2080
  ds_read_b64_tr_b16 v[30:31], v3 offset:2336
  s_waitcnt lgkmcnt(0)
  s_add_u32 s37, s35, 36928
  buffer_store_dwordx4 v[28:31], v8, s[20:23], s37 offen
  s_waitcnt vmcnt(7)
  ds_read_b64_tr_b16 v[32:33], v3 offset:4096
  ds_read_b64_tr_b16 v[34:35], v3 offset:4352
  s_waitcnt lgkmcnt(0)
  s_add_u32 s37, s35, 128
  buffer_store_dwordx4 v[32:35], v8, s[20:23], s37 offen
  ds_read_b64_tr_b16 v[36:37], v3 offset:4128
  ds_read_b64_tr_b16 v[38:39], v3 offset:4384
  s_waitcnt lgkmcnt(0)
  s_add_u32 s37, s35, 36992
  buffer_store_dwordx4 v[36:39], v8, s[20:23], s37 offen
  s_waitcnt vmcnt(7)
  ds_read_b64_tr_b16 v[40:41], v3 offset:6144
  ds_read_b64_tr_b16 v[42:43], v3 offset:6400
  s_waitcnt lgkmcnt(0)
  s_add_u32 s37, s35, 192
  buffer_store_dwordx4 v[40:43], v8, s[20:23], s37 offen
  ds_read_b64_tr_b16 v[44:45], v3 offset:6176
  ds_read_b64_tr_b16 v[46:47], v3 offset:6432
  s_waitcnt lgkmcnt(0)
  s_add_u32 s37, s35, 37056
  buffer_store_dwordx4 v[44:47], v8, s[20:23], s37 offen
  s_waitcnt vmcnt(8)
  ds_read_b64_tr_b16 v[48:49], v3 offset:8192
  ds_read_b64_tr_b16 v[50:51], v3 offset:8448
  s_waitcnt lgkmcnt(0)
  s_add_u32 s37, s35, 256
  buffer_store_dwordx4 v[48:51], v10, s[20:23], s37 offen
  ds_read_b64_tr_b16 v[52:53], v3 offset:8224
  ds_read_b64_tr_b16 v[54:55], v3 offset:8480
  s_waitcnt lgkmcnt(0)
  s_add_u32 s37, s35, 37120
  buffer_store_dwordx4 v[52:55], v10, s[20:23], s37 offen
  s_endpgm
l3_kernel_end:
  s_endpgm
.section .rodata,"a"
.p2align 6
.amdhsa_kernel l3_kernel
  .amdhsa_next_free_vgpr 160
  .amdhsa_next_free_sgpr 102
  .amdhsa_accum_offset 160
  .amdhsa_group_segment_fixed_size 0
  .amdhsa_kernarg_size 120
  .amdhsa_user_sgpr_count 2
  .amdhsa_user_sgpr_kernarg_segment_ptr 1
  .amdhsa_system_sgpr_workgroup_id_x 1
.end_amdhsa_kernel
.text
text_end:
```
